```python
import torch

def _softmax(x, axis=-1):
    return torch.softmax(x, dim=axis)
def _gelu(x):
    return torch.nn.functional.gelu(x, approximate="tanh")
def _silu(x):
    return torch.nn.functional.silu(x)
def _sigmoid(x):
    return torch.sigmoid(x)
def _layernorm(x, axis=-1, eps=1e-5):
    m = x.mean(dim=axis, keepdim=True)
    v = x.var(dim=axis, keepdim=True, unbiased=False)
    return (x - m) / torch.sqrt(v + eps)
def _scatter_add(tgt, idx, src, axis=0):
    return tgt.clone().index_add_(axis, idx, src)
def _segment_sum(src, seg, n):
    out = torch.zeros((n,) + src.shape[1:], dtype=src.dtype)
    return out.index_add_(0, seg, src)
def _pad(x, pw):
    flat = tuple(v for pair in reversed(pw) for v in pair)
    return torch.nn.functional.pad(x, flat)

kernel_name = 'standalone__gqa_block_cached__near_ridge'

def setup_inputs():

    _w = (lambda a: (lambda t: t.to(torch.bfloat16) if t.is_floating_point() else t)(torch.as_tensor(a)))
    B, Sq, D = 16, 32, 1024
    Hq, Hkv, Sk, Dh = 32, 4, 512, 128
    assert Hq % Hkv == 0, (Hq, Hkv)
    return {
        "x": _w((lambda *s: torch.randn(*s, dtype=torch.bfloat16) * 0.8)(B, Sq, D)),
        "k_cache": _w((lambda *s: torch.randn(*s, dtype=torch.bfloat16) * 0.8)(B, Hkv, Sk, Dh)),
        "v_cache": _w((lambda *s: torch.randn(*s, dtype=torch.bfloat16) * 0.05)(B, Hkv, Sk, Dh)),
        "wq": _w((lambda *s: torch.randn(*s, dtype=torch.bfloat16) * 0.8)(D, Hq * Dh) * (D ** -0.5)),
        "wo": _w((lambda *s: torch.randn(*s, dtype=torch.bfloat16) * 0.05)(Hq * Dh, D) * ((Hq * Dh) ** -0.5)),
    }

def reference(x, k_cache, v_cache, wq, wo):
    B, Sq, D = x.shape
    Hq, Dh = 32, 128
    Hkv = k_cache.shape[1]
    rep = Hq // Hkv
    q = (lambda x, *d: x.permute(*d))((x @ wq).reshape(B, Sq, Hq, Dh), 0, 2, 1, 3)
    k = (lambda x, n, axis: torch.repeat_interleave(x, n, dim=axis))(k_cache, rep, axis=1)
    v = (lambda x, n, axis: torch.repeat_interleave(x, n, dim=axis))(v_cache, rep, axis=1)
    scores = torch.einsum("bhqd,bhkd->bhqk", q, k) * (Dh ** -0.5)
    p = _softmax(scores, axis=-1)
    o = torch.einsum("bhqk,bhkd->bhqd", p, v)
    return (lambda x, *d: x.permute(*d))(o, 0, 2, 1, 3).reshape(B, Sq, Hq * Dh) @ wo
```

```asm
; @launch grid=(256,1,1) block=(512,1,1) lds=163840
.amdgcn_target "amdgcn-amd-amdhsa--gfx950"
.text
.globl standalone__gqa_block_cached__near_ridge_kernel
.p2align 8
.type standalone__gqa_block_cached__near_ridge_kernel,@function
standalone__gqa_block_cached__near_ridge_kernel:
  s_cmp_ge_u32 s2, 256
  s_cbranch_scc1 standalone__gqa_block_cached__near_ridge_kernel_end
  s_getpc_b64 s[36:37]
standalone__gqa_block_cached__near_ridge_kernel_pc_1:
  v_lshlrev_b32 v57, 6, v0
  s_sub_u32 s36, s36, standalone__gqa_block_cached__near_ridge_kernel_pc_1-standalone__gqa_block_cached__near_ridge_kernel
  s_subb_u32 s37, s37, 0
  v_min_u32 v57, standalone__gqa_block_cached__near_ridge_kernel_end-standalone__gqa_block_cached__near_ridge_kernel, v57
  global_load_dword v58, v57, s[36:37]
  s_load_dwordx8 s[4:11], s[0:1], 0
  s_load_dwordx4 s[12:15], s[0:1], 32
  s_load_dwordx4 s[16:19], s[0:1], 48
  v_lshrrev_b32 v2, 6, v0
  v_and_b32 v1, 63, v0
  v_readfirstlane_b32 s23, v2
  s_and_b32 s24, s2, 7
  s_lshr_b32 s25, s2, 3
  s_lshr_b32 s20, s24, 1
  s_and_b32 s24, s24, 1
  s_lshl_b32 s24, s24, 2
  s_lshr_b32 s21, s25, 3
  s_add_u32 s21, s21, s24
  s_and_b32 s22, s25, 7
  s_cmp_lt_u32 s23, 4
  s_cbranch_scc1 standalone__gqa_block_cached__near_ridge_kernel_compute_2
  s_sub_u32 s27, s23, 4
  v_lshrrev_b32 v5, 3, v1
  v_lshrrev_b32 v2, 4, v1
  v_and_b32 v4, 7, v1
  v_xor_b32 v4, v4, v2
  v_lshlrev_b32 v4, 4, v4
  v_lshl_add_u32 v8, v5, 11, v4
  s_lshl_b32 s24, s27, 15
  v_add_u32 v8, s24, v8
  v_xor_b32 v9, 64, v8
  v_add_u32 v9, 15360, v9
  v_and_b32 v3, 15, v1
  v_lshlrev_b32 v4, 2, v2
  v_xor_b32 v4, v4, v3
  v_lshlrev_b32 v4, 4, v4
  s_lshl_b32 s24, s27, 3
  v_add_u32 v5, s24, v2
  v_lshl_add_u32 v10, v5, 13, v4
  v_add_u32 v11, 31744, v10
  s_lshl_b32 s72, s27, 11
  s_lshr_b32 s24, s21, 2
  s_add_u32 s24, s24, s22
  s_lshl_b32 s24, s24, 1
  s_and_b32 s25, s21, 3
  s_lshl_b32 s25, s25, 2
  s_add_u32 s74, s24, s25
  s_lshl_b32 s24, s21, 17
  s_lshl_b32 s26, s20, 3
  s_add_u32 s26, s26, s22
  s_lshl_b32 s26, s26, 8
  s_sub_u32 s25, 8388608, s26
  s_waitcnt lgkmcnt(0)
  s_add_u32 s32, s4, s24
  s_addc_u32 s33, s5, 0
  s_mov_b32 s34, 131072
  s_mov_b32 s35, 0x20000
  s_add_u32 s36, s10, s26
  s_addc_u32 s37, s11, 0
  s_mov_b32 s38, s25
  s_mov_b32 s39, 0x20000
  s_add_u32 s73, s74, 0
  s_and_b32 s73, s73, 15
  s_lshl_b32 s73, s73, 7
  s_add_u32 m0, s72, 0
  s_nop 0
  buffer_load_dwordx4 v8, s[32:35], s73 offen lds
  buffer_load_dwordx4 v9, s[32:35], s73 offen offset:1024 lds
  s_add_u32 s73, s74, 0
  s_and_b32 s73, s73, 15
  s_lshl_b32 s73, s73, 19
  s_add_u32 m0, s72, 32768
  s_nop 0
  buffer_load_dwordx4 v10, s[36:39], s73 offen lds
  buffer_load_dwordx4 v11, s[36:39], s73 offen offset:1024 lds
  s_add_u32 s73, s74, 0
  s_and_b32 s73, s73, 15
  s_lshl_b32 s73, s73, 19
  s_add_u32 s73, s73, 262144
  s_add_u32 m0, s72, 40960
  s_nop 0
  buffer_load_dwordx4 v10, s[36:39], s73 offen lds
  buffer_load_dwordx4 v11, s[36:39], s73 offen offset:1024 lds
  s_add_u32 s73, s74, 1
  s_and_b32 s73, s73, 15
  s_lshl_b32 s73, s73, 7
  s_add_u32 m0, s72, 8192
  s_nop 0
  buffer_load_dwordx4 v8, s[32:35], s73 offen lds
  buffer_load_dwordx4 v9, s[32:35], s73 offen offset:1024 lds
  s_add_u32 s73, s74, 1
  s_and_b32 s73, s73, 15
  s_lshl_b32 s73, s73, 19
  s_add_u32 m0, s72, 49152
  s_nop 0
  buffer_load_dwordx4 v10, s[36:39], s73 offen lds
  buffer_load_dwordx4 v11, s[36:39], s73 offen offset:1024 lds
  s_add_u32 s73, s74, 1
  s_and_b32 s73, s73, 15
  s_lshl_b32 s73, s73, 19
  s_add_u32 s73, s73, 262144
  s_add_u32 m0, s72, 57344
  s_nop 0
  buffer_load_dwordx4 v10, s[36:39], s73 offen lds
  buffer_load_dwordx4 v11, s[36:39], s73 offen offset:1024 lds
  s_add_u32 s73, s74, 2
  s_and_b32 s73, s73, 15
  s_lshl_b32 s73, s73, 7
  s_add_u32 m0, s72, 16384
  s_nop 0
  buffer_load_dwordx4 v8, s[32:35], s73 offen lds
  buffer_load_dwordx4 v9, s[32:35], s73 offen offset:1024 lds
  s_add_u32 s73, s74, 2
  s_and_b32 s73, s73, 15
  s_lshl_b32 s73, s73, 19
  s_add_u32 m0, s72, 65536
  s_nop 0
  buffer_load_dwordx4 v10, s[36:39], s73 offen lds
  buffer_load_dwordx4 v11, s[36:39], s73 offen offset:1024 lds
  s_add_u32 s73, s74, 2
  s_and_b32 s73, s73, 15
  s_lshl_b32 s73, s73, 19
  s_add_u32 s73, s73, 262144
  s_add_u32 m0, s72, 73728
  s_nop 0
  buffer_load_dwordx4 v10, s[36:39], s73 offen lds
  buffer_load_dwordx4 v11, s[36:39], s73 offen offset:1024 lds
  s_mov_b32 s76, s74
  s_and_b32 s75, s22, 6
  v_lshl_add_u32 v16, v5, 11, v4
  v_add_u32 v17, 7168, v16
  v_lshl_add_u32 v14, v5, 8, v4
  v_add_u32 v6, 0, v5
  v_and_b32 v6, 15, v6
  v_xor_b32 v6, v6, v3
  v_lshlrev_b32 v6, 4, v6
  v_lshl_add_u32 v12, v5, 8, v6
  v_add_u32 v6, 4, v5
  v_and_b32 v6, 15, v6
  v_xor_b32 v6, v6, v3
  v_lshlrev_b32 v6, 4, v6
  v_lshl_add_u32 v13, v5, 8, v6
  s_lshr_b32 s24, s27, 1
  s_lshl_b32 s24, s24, 18
  s_and_b32 s25, s27, 1
  s_lshl_b32 s25, s25, 11
  s_add_u32 s24, s24, s25
  v_lshl_add_u32 v15, v1, 4, s24
  s_and_b32 s24, s22, 1
  s_lshl_b32 s25, s21, 1
  s_add_u32 s24, s24, s25
  s_lshl_b32 s24, s24, 2
  s_add_u32 s24, s24, s20
  s_lshl_b32 s24, s24, 17
  s_add_u32 s40, s6, s24
  s_addc_u32 s41, s7, 0
  s_mov_b32 s42, 131072
  s_mov_b32 s43, 0x20000
  s_add_u32 s44, s8, s24
  s_addc_u32 s45, s9, 0
  s_mov_b32 s46, 131072
  s_mov_b32 s47, 0x20000
  s_lshl_b32 s24, s21, 6
  s_lshl_b32 s25, s20, 3
  s_add_u32 s24, s24, s25
  s_lshl_b32 s24, s24, 13
  s_add_u32 s24, s24, 4194304
  s_add_u32 s52, s18, s24
  s_addc_u32 s53, s19, 0
  s_mov_b32 s54, 327680
  s_mov_b32 s55, 0x20000
  s_add_u32 s25, s22, 2
  s_and_b32 s25, s25, 7
  s_lshl_b32 s25, s25, 8
  s_lshl_b32 s24, s20, 21
  s_add_u32 s24, s24, s25
  s_sub_u32 s25, 8388608, s24
  s_add_u32 s56, s12, s24
  s_addc_u32 s57, s13, 0
  s_mov_b32 s58, s25
  s_mov_b32 s59, 0x20000
  v_lshlrev_b32 v29, 7, v1
  s_lshl_b32 s24, s27, 11
  v_add_u32 v29, s24, v29
  s_waitcnt vmcnt(12)
  s_barrier
  s_add_u32 s73, s74, 3
  s_and_b32 s73, s73, 15
  s_lshl_b32 s73, s73, 7
  s_add_u32 m0, s72, 24576
  s_nop 0
  buffer_load_dwordx4 v8, s[32:35], s73 offen lds
  buffer_load_dwordx4 v9, s[32:35], s73 offen offset:1024 lds
  s_add_u32 s73, s74, 3
  s_and_b32 s73, s73, 15
  s_lshl_b32 s73, s73, 19
  s_add_u32 m0, s72, 81920
  s_nop 0
  buffer_load_dwordx4 v10, s[36:39], s73 offen lds
  buffer_load_dwordx4 v11, s[36:39], s73 offen offset:1024 lds
  s_add_u32 s73, s74, 3
  s_and_b32 s73, s73, 15
  s_lshl_b32 s73, s73, 19
  s_add_u32 s73, s73, 262144
  s_add_u32 m0, s72, 90112
  s_nop 0
  buffer_load_dwordx4 v10, s[36:39], s73 offen lds
  buffer_load_dwordx4 v11, s[36:39], s73 offen offset:1024 lds
  s_waitcnt vmcnt(12)
  s_barrier
  s_add_u32 s73, s74, 4
  s_and_b32 s73, s73, 15
  s_lshl_b32 s73, s73, 7
  s_add_u32 m0, s72, 0
  s_nop 0
  buffer_load_dwordx4 v8, s[32:35], s73 offen lds
  buffer_load_dwordx4 v9, s[32:35], s73 offen offset:1024 lds
  s_add_u32 s73, s74, 4
  s_and_b32 s73, s73, 15
  s_lshl_b32 s73, s73, 19
  s_add_u32 m0, s72, 32768
  s_nop 0
  buffer_load_dwordx4 v10, s[36:39], s73 offen lds
  buffer_load_dwordx4 v11, s[36:39], s73 offen offset:1024 lds
  s_add_u32 s73, s74, 4
  s_and_b32 s73, s73, 15
  s_lshl_b32 s73, s73, 19
  s_add_u32 s73, s73, 262144
  s_add_u32 m0, s72, 40960
  s_nop 0
  buffer_load_dwordx4 v10, s[36:39], s73 offen lds
  buffer_load_dwordx4 v11, s[36:39], s73 offen offset:1024 lds
  s_waitcnt vmcnt(12)
  s_barrier
  s_add_u32 s73, s74, 5
  s_and_b32 s73, s73, 15
  s_lshl_b32 s73, s73, 7
  s_add_u32 m0, s72, 8192
  s_nop 0
  buffer_load_dwordx4 v8, s[32:35], s73 offen lds
  buffer_load_dwordx4 v9, s[32:35], s73 offen offset:1024 lds
  s_add_u32 s73, s74, 5
  s_and_b32 s73, s73, 15
  s_lshl_b32 s73, s73, 19
  s_add_u32 m0, s72, 49152
  s_nop 0
  buffer_load_dwordx4 v10, s[36:39], s73 offen lds
  buffer_load_dwordx4 v11, s[36:39], s73 offen offset:1024 lds
  s_add_u32 s73, s74, 5
  s_and_b32 s73, s73, 15
  s_lshl_b32 s73, s73, 19
  s_add_u32 s73, s73, 262144
  s_add_u32 m0, s72, 57344
  s_nop 0
  buffer_load_dwordx4 v10, s[36:39], s73 offen lds
  buffer_load_dwordx4 v11, s[36:39], s73 offen offset:1024 lds
  s_waitcnt vmcnt(12)
  s_barrier
  s_add_u32 s73, s74, 6
  s_and_b32 s73, s73, 15
  s_lshl_b32 s73, s73, 7
  s_add_u32 m0, s72, 16384
  s_nop 0
  buffer_load_dwordx4 v8, s[32:35], s73 offen lds
  buffer_load_dwordx4 v9, s[32:35], s73 offen offset:1024 lds
  s_add_u32 s73, s74, 6
  s_and_b32 s73, s73, 15
  s_lshl_b32 s73, s73, 19
  s_add_u32 m0, s72, 65536
  s_nop 0
  buffer_load_dwordx4 v10, s[36:39], s73 offen lds
  buffer_load_dwordx4 v11, s[36:39], s73 offen offset:1024 lds
  s_add_u32 s73, s74, 6
  s_and_b32 s73, s73, 15
  s_lshl_b32 s73, s73, 19
  s_add_u32 s73, s73, 262144
  s_add_u32 m0, s72, 73728
  s_nop 0
  buffer_load_dwordx4 v10, s[36:39], s73 offen lds
  buffer_load_dwordx4 v11, s[36:39], s73 offen offset:1024 lds
  s_waitcnt vmcnt(12)
  s_barrier
  s_add_u32 s73, s74, 7
  s_and_b32 s73, s73, 15
  s_lshl_b32 s73, s73, 7
  s_add_u32 m0, s72, 24576
  s_nop 0
  buffer_load_dwordx4 v8, s[32:35], s73 offen lds
  buffer_load_dwordx4 v9, s[32:35], s73 offen offset:1024 lds
  s_add_u32 s73, s74, 7
  s_and_b32 s73, s73, 15
  s_lshl_b32 s73, s73, 19
  s_add_u32 m0, s72, 81920
  s_nop 0
  buffer_load_dwordx4 v10, s[36:39], s73 offen lds
  buffer_load_dwordx4 v11, s[36:39], s73 offen offset:1024 lds
  s_add_u32 s73, s74, 7
  s_and_b32 s73, s73, 15
  s_lshl_b32 s73, s73, 19
  s_add_u32 s73, s73, 262144
  s_add_u32 m0, s72, 90112
  s_nop 0
  buffer_load_dwordx4 v10, s[36:39], s73 offen lds
  buffer_load_dwordx4 v11, s[36:39], s73 offen offset:1024 lds
  s_waitcnt vmcnt(12)
  s_barrier
  s_add_u32 s73, s74, 8
  s_and_b32 s73, s73, 15
  s_lshl_b32 s73, s73, 7
  s_add_u32 m0, s72, 0
  s_nop 0
  buffer_load_dwordx4 v8, s[32:35], s73 offen lds
  buffer_load_dwordx4 v9, s[32:35], s73 offen offset:1024 lds
  s_add_u32 s73, s74, 8
  s_and_b32 s73, s73, 15
  s_lshl_b32 s73, s73, 19
  s_add_u32 m0, s72, 32768
  s_nop 0
  buffer_load_dwordx4 v10, s[36:39], s73 offen lds
  buffer_load_dwordx4 v11, s[36:39], s73 offen offset:1024 lds
  s_add_u32 s73, s74, 8
  s_and_b32 s73, s73, 15
  s_lshl_b32 s73, s73, 19
  s_add_u32 s73, s73, 262144
  s_add_u32 m0, s72, 40960
  s_nop 0
  buffer_load_dwordx4 v10, s[36:39], s73 offen lds
  buffer_load_dwordx4 v11, s[36:39], s73 offen offset:1024 lds
  s_waitcnt vmcnt(12)
  s_barrier
  s_add_u32 s73, s74, 9
  s_and_b32 s73, s73, 15
  s_lshl_b32 s73, s73, 7
  s_add_u32 m0, s72, 8192
  s_nop 0
  buffer_load_dwordx4 v8, s[32:35], s73 offen lds
  buffer_load_dwordx4 v9, s[32:35], s73 offen offset:1024 lds
  s_add_u32 s73, s74, 9
  s_and_b32 s73, s73, 15
  s_lshl_b32 s73, s73, 19
  s_add_u32 m0, s72, 49152
  s_nop 0
  buffer_load_dwordx4 v10, s[36:39], s73 offen lds
  buffer_load_dwordx4 v11, s[36:39], s73 offen offset:1024 lds
  s_add_u32 s73, s74, 9
  s_and_b32 s73, s73, 15
  s_lshl_b32 s73, s73, 19
  s_add_u32 s73, s73, 262144
  s_add_u32 m0, s72, 57344
  s_nop 0
  buffer_load_dwordx4 v10, s[36:39], s73 offen lds
  buffer_load_dwordx4 v11, s[36:39], s73 offen offset:1024 lds
  s_waitcnt vmcnt(12)
  s_barrier
  s_add_u32 s73, s74, 10
  s_and_b32 s73, s73, 15
  s_lshl_b32 s73, s73, 7
  s_add_u32 m0, s72, 16384
  s_nop 0
  buffer_load_dwordx4 v8, s[32:35], s73 offen lds
  buffer_load_dwordx4 v9, s[32:35], s73 offen offset:1024 lds
  s_add_u32 s73, s74, 10
  s_and_b32 s73, s73, 15
  s_lshl_b32 s73, s73, 19
  s_add_u32 m0, s72, 65536
  s_nop 0
  buffer_load_dwordx4 v10, s[36:39], s73 offen lds
  buffer_load_dwordx4 v11, s[36:39], s73 offen offset:1024 lds
  s_add_u32 s73, s74, 10
  s_and_b32 s73, s73, 15
  s_lshl_b32 s73, s73, 19
  s_add_u32 s73, s73, 262144
  s_add_u32 m0, s72, 73728
  s_nop 0
  buffer_load_dwordx4 v10, s[36:39], s73 offen lds
  buffer_load_dwordx4 v11, s[36:39], s73 offen offset:1024 lds
  s_waitcnt vmcnt(12)
  s_barrier
  s_add_u32 s73, s74, 11
  s_and_b32 s73, s73, 15
  s_lshl_b32 s73, s73, 7
  s_add_u32 m0, s72, 24576
  s_nop 0
  buffer_load_dwordx4 v8, s[32:35], s73 offen lds
  buffer_load_dwordx4 v9, s[32:35], s73 offen offset:1024 lds
  s_add_u32 s73, s74, 11
  s_and_b32 s73, s73, 15
  s_lshl_b32 s73, s73, 19
  s_add_u32 m0, s72, 81920
  s_nop 0
  buffer_load_dwordx4 v10, s[36:39], s73 offen lds
  buffer_load_dwordx4 v11, s[36:39], s73 offen offset:1024 lds
  s_add_u32 s73, s74, 11
  s_and_b32 s73, s73, 15
  s_lshl_b32 s73, s73, 19
  s_add_u32 s73, s73, 262144
  s_add_u32 m0, s72, 90112
  s_nop 0
  buffer_load_dwordx4 v10, s[36:39], s73 offen lds
  buffer_load_dwordx4 v11, s[36:39], s73 offen offset:1024 lds
  s_waitcnt vmcnt(12)
  s_barrier
  s_add_u32 s73, s74, 12
  s_and_b32 s73, s73, 15
  s_lshl_b32 s73, s73, 7
  s_add_u32 m0, s72, 0
  s_nop 0
  buffer_load_dwordx4 v8, s[32:35], s73 offen lds
  buffer_load_dwordx4 v9, s[32:35], s73 offen offset:1024 lds
  s_add_u32 s73, s74, 12
  s_and_b32 s73, s73, 15
  s_lshl_b32 s73, s73, 19
  s_add_u32 m0, s72, 32768
  s_nop 0
  buffer_load_dwordx4 v10, s[36:39], s73 offen lds
  buffer_load_dwordx4 v11, s[36:39], s73 offen offset:1024 lds
  s_add_u32 s73, s74, 12
  s_and_b32 s73, s73, 15
  s_lshl_b32 s73, s73, 19
  s_add_u32 s73, s73, 262144
  s_add_u32 m0, s72, 40960
  s_nop 0
  buffer_load_dwordx4 v10, s[36:39], s73 offen lds
  buffer_load_dwordx4 v11, s[36:39], s73 offen offset:1024 lds
  s_waitcnt vmcnt(12)
  s_barrier
  s_add_u32 s73, s74, 13
  s_and_b32 s73, s73, 15
  s_lshl_b32 s73, s73, 7
  s_add_u32 m0, s72, 8192
  s_nop 0
  buffer_load_dwordx4 v8, s[32:35], s73 offen lds
  buffer_load_dwordx4 v9, s[32:35], s73 offen offset:1024 lds
  s_add_u32 s73, s74, 13
  s_and_b32 s73, s73, 15
  s_lshl_b32 s73, s73, 19
  s_add_u32 m0, s72, 49152
  s_nop 0
  buffer_load_dwordx4 v10, s[36:39], s73 offen lds
  buffer_load_dwordx4 v11, s[36:39], s73 offen offset:1024 lds
  s_add_u32 s73, s74, 13
  s_and_b32 s73, s73, 15
  s_lshl_b32 s73, s73, 19
  s_add_u32 s73, s73, 262144
  s_add_u32 m0, s72, 57344
  s_nop 0
  buffer_load_dwordx4 v10, s[36:39], s73 offen lds
  buffer_load_dwordx4 v11, s[36:39], s73 offen offset:1024 lds
  s_waitcnt vmcnt(12)
  s_barrier
  s_add_u32 s73, s74, 14
  s_and_b32 s73, s73, 15
  s_lshl_b32 s73, s73, 7
  s_add_u32 m0, s72, 16384
  s_nop 0
  buffer_load_dwordx4 v8, s[32:35], s73 offen lds
  buffer_load_dwordx4 v9, s[32:35], s73 offen offset:1024 lds
  s_add_u32 s73, s74, 14
  s_and_b32 s73, s73, 15
  s_lshl_b32 s73, s73, 19
  s_add_u32 m0, s72, 65536
  s_nop 0
  buffer_load_dwordx4 v10, s[36:39], s73 offen lds
  buffer_load_dwordx4 v11, s[36:39], s73 offen offset:1024 lds
  s_add_u32 s73, s74, 14
  s_and_b32 s73, s73, 15
  s_lshl_b32 s73, s73, 19
  s_add_u32 s73, s73, 262144
  s_add_u32 m0, s72, 73728
  s_nop 0
  buffer_load_dwordx4 v10, s[36:39], s73 offen lds
  buffer_load_dwordx4 v11, s[36:39], s73 offen offset:1024 lds
  s_waitcnt vmcnt(12)
  s_barrier
  s_add_u32 s73, s74, 15
  s_and_b32 s73, s73, 15
  s_lshl_b32 s73, s73, 7
  s_add_u32 m0, s72, 24576
  s_nop 0
  buffer_load_dwordx4 v8, s[32:35], s73 offen lds
  buffer_load_dwordx4 v9, s[32:35], s73 offen offset:1024 lds
  s_add_u32 s73, s74, 15
  s_and_b32 s73, s73, 15
  s_lshl_b32 s73, s73, 19
  s_add_u32 m0, s72, 81920
  s_nop 0
  buffer_load_dwordx4 v10, s[36:39], s73 offen lds
  buffer_load_dwordx4 v11, s[36:39], s73 offen offset:1024 lds
  s_add_u32 s73, s74, 15
  s_and_b32 s73, s73, 15
  s_lshl_b32 s73, s73, 19
  s_add_u32 s73, s73, 262144
  s_add_u32 m0, s72, 90112
  s_nop 0
  buffer_load_dwordx4 v10, s[36:39], s73 offen lds
  buffer_load_dwordx4 v11, s[36:39], s73 offen offset:1024 lds
  s_waitcnt vmcnt(12)
  s_barrier
  s_add_u32 s73, s75, 0
  s_and_b32 s73, s73, 7
  s_lshl_b32 s73, s73, 13
  s_add_u32 m0, s72, 98304
  s_nop 0
  buffer_load_dwordx4 v12, s[40:43], s73 offen lds
  buffer_load_dwordx4 v13, s[40:43], s73 offen offset:1024 lds
  s_add_u32 s73, s75, 0
  s_and_b32 s73, s73, 7
  s_lshl_b32 s73, s73, 13
  s_add_u32 s73, s73, 65536
  s_add_u32 m0, s72, 106496
  s_nop 0
  buffer_load_dwordx4 v12, s[40:43], s73 offen lds
  buffer_load_dwordx4 v13, s[40:43], s73 offen offset:1024 lds
  s_waitcnt vmcnt(10)
  s_barrier
  s_add_u32 s73, s75, 1
  s_and_b32 s73, s73, 7
  s_lshl_b32 s73, s73, 13
  s_add_u32 m0, s72, 114688
  s_nop 0
  buffer_load_dwordx4 v12, s[40:43], s73 offen lds
  buffer_load_dwordx4 v13, s[40:43], s73 offen offset:1024 lds
  s_add_u32 s73, s75, 1
  s_and_b32 s73, s73, 7
  s_lshl_b32 s73, s73, 13
  s_add_u32 s73, s73, 65536
  s_add_u32 m0, s72, 122880
  s_nop 0
  buffer_load_dwordx4 v12, s[40:43], s73 offen lds
  buffer_load_dwordx4 v13, s[40:43], s73 offen offset:1024 lds
  s_waitcnt vmcnt(8)
  s_barrier
  s_add_u32 s73, s75, 2
  s_and_b32 s73, s73, 7
  s_lshl_b32 s73, s73, 13
  s_add_u32 m0, s72, 131072
  s_nop 0
  buffer_load_dwordx4 v12, s[40:43], s73 offen lds
  buffer_load_dwordx4 v13, s[40:43], s73 offen offset:1024 lds
  s_add_u32 s73, s75, 2
  s_and_b32 s73, s73, 7
  s_lshl_b32 s73, s73, 13
  s_add_u32 s73, s73, 65536
  s_add_u32 m0, s72, 139264
  s_nop 0
  buffer_load_dwordx4 v12, s[40:43], s73 offen lds
  buffer_load_dwordx4 v13, s[40:43], s73 offen offset:1024 lds
  s_barrier
  s_add_u32 s73, s75, 3
  s_and_b32 s73, s73, 7
  s_lshl_b32 s73, s73, 13
  s_add_u32 m0, s72, 147456
  s_nop 0
  buffer_load_dwordx4 v12, s[40:43], s73 offen lds
  buffer_load_dwordx4 v13, s[40:43], s73 offen offset:1024 lds
  s_add_u32 s73, s75, 3
  s_and_b32 s73, s73, 7
  s_lshl_b32 s73, s73, 13
  s_add_u32 s73, s73, 65536
  s_add_u32 m0, s72, 155648
  s_nop 0
  buffer_load_dwordx4 v12, s[40:43], s73 offen lds
  buffer_load_dwordx4 v13, s[40:43], s73 offen offset:1024 lds
  s_barrier
  s_waitcnt vmcnt(10)
  s_add_u32 s73, s75, 4
  s_and_b32 s73, s73, 7
  s_lshl_b32 s73, s73, 13
  s_add_u32 m0, s72, 32768
  s_nop 0
  buffer_load_dwordx4 v12, s[40:43], s73 offen lds
  buffer_load_dwordx4 v13, s[40:43], s73 offen offset:1024 lds
  s_waitcnt vmcnt(10)
  s_add_u32 s73, s75, 4
  s_and_b32 s73, s73, 7
  s_lshl_b32 s73, s73, 13
  s_add_u32 s73, s73, 65536
  s_add_u32 m0, s72, 40960
  s_nop 0
  buffer_load_dwordx4 v12, s[40:43], s73 offen lds
  buffer_load_dwordx4 v13, s[40:43], s73 offen offset:1024 lds
  s_waitcnt vmcnt(10)
  s_add_u32 s73, s75, 5
  s_and_b32 s73, s73, 7
  s_lshl_b32 s73, s73, 13
  s_add_u32 m0, s72, 49152
  s_nop 0
  buffer_load_dwordx4 v12, s[40:43], s73 offen lds
  buffer_load_dwordx4 v13, s[40:43], s73 offen offset:1024 lds
  s_waitcnt vmcnt(10)
  s_add_u32 s73, s75, 5
  s_and_b32 s73, s73, 7
  s_lshl_b32 s73, s73, 13
  s_add_u32 s73, s73, 65536
  s_add_u32 m0, s72, 57344
  s_nop 0
  buffer_load_dwordx4 v12, s[40:43], s73 offen lds
  buffer_load_dwordx4 v13, s[40:43], s73 offen offset:1024 lds
  s_barrier
  s_add_u32 s73, s75, 6
  s_and_b32 s73, s73, 7
  s_lshl_b32 s73, s73, 13
  s_add_u32 m0, s72, 65536
  s_nop 0
  buffer_load_dwordx4 v12, s[40:43], s73 offen lds
  buffer_load_dwordx4 v13, s[40:43], s73 offen offset:1024 lds
  s_add_u32 s73, s75, 6
  s_and_b32 s73, s73, 7
  s_lshl_b32 s73, s73, 13
  s_add_u32 s73, s73, 65536
  s_add_u32 m0, s72, 73728
  s_nop 0
  buffer_load_dwordx4 v12, s[40:43], s73 offen lds
  buffer_load_dwordx4 v13, s[40:43], s73 offen offset:1024 lds
  s_waitcnt vmcnt(14)
  s_add_u32 s73, s75, 7
  s_and_b32 s73, s73, 7
  s_lshl_b32 s73, s73, 13
  s_add_u32 m0, s72, 81920
  s_nop 0
  buffer_load_dwordx4 v12, s[40:43], s73 offen lds
  buffer_load_dwordx4 v13, s[40:43], s73 offen offset:1024 lds
  s_waitcnt vmcnt(14)
  s_add_u32 s73, s75, 7
  s_and_b32 s73, s73, 7
  s_lshl_b32 s73, s73, 13
  s_add_u32 s73, s73, 65536
  s_add_u32 m0, s72, 90112
  s_nop 0
  buffer_load_dwordx4 v12, s[40:43], s73 offen lds
  buffer_load_dwordx4 v13, s[40:43], s73 offen offset:1024 lds
  s_barrier
  s_waitcnt vmcnt(14)
  s_add_u32 s73, s75, 0
  s_and_b32 s73, s73, 7
  s_lshl_b32 s73, s73, 13
  s_add_u32 m0, s72, 0
  s_nop 0
  buffer_load_dwordx4 v14, s[44:47], s73 offen lds
  buffer_load_dwordx4 v14, s[44:47], s73 offen offset:1024 lds
  s_waitcnt vmcnt(14)
  s_add_u32 s73, s75, 0
  s_and_b32 s73, s73, 7
  s_lshl_b32 s73, s73, 13
  s_add_u32 s73, s73, 65536
  s_add_u32 m0, s72, 8192
  s_nop 0
  buffer_load_dwordx4 v14, s[44:47], s73 offen lds
  buffer_load_dwordx4 v14, s[44:47], s73 offen offset:1024 lds
  s_waitcnt vmcnt(14)
  s_add_u32 s73, s75, 1
  s_and_b32 s73, s73, 7
  s_lshl_b32 s73, s73, 13
  s_add_u32 m0, s72, 16384
  s_nop 0
  buffer_load_dwordx4 v14, s[44:47], s73 offen lds
  buffer_load_dwordx4 v14, s[44:47], s73 offen offset:1024 lds
  s_waitcnt vmcnt(14)
  s_add_u32 s73, s75, 1
  s_and_b32 s73, s73, 7
  s_lshl_b32 s73, s73, 13
  s_add_u32 s73, s73, 65536
  s_add_u32 m0, s72, 24576
  s_nop 0
  buffer_load_dwordx4 v14, s[44:47], s73 offen lds
  buffer_load_dwordx4 v14, s[44:47], s73 offen offset:1024 lds
  s_barrier
  s_waitcnt vmcnt(14)
  s_add_u32 s73, s75, 2
  s_and_b32 s73, s73, 7
  s_lshl_b32 s73, s73, 13
  s_add_u32 m0, s72, 98304
  s_nop 0
  buffer_load_dwordx4 v14, s[44:47], s73 offen lds
  buffer_load_dwordx4 v14, s[44:47], s73 offen offset:1024 lds
  s_waitcnt vmcnt(14)
  s_add_u32 s73, s75, 2
  s_and_b32 s73, s73, 7
  s_lshl_b32 s73, s73, 13
  s_add_u32 s73, s73, 65536
  s_add_u32 m0, s72, 106496
  s_nop 0
  buffer_load_dwordx4 v14, s[44:47], s73 offen lds
  buffer_load_dwordx4 v14, s[44:47], s73 offen offset:1024 lds
  s_barrier
  s_waitcnt vmcnt(14)
  s_add_u32 s73, s75, 3
  s_and_b32 s73, s73, 7
  s_lshl_b32 s73, s73, 13
  s_add_u32 m0, s72, 114688
  s_nop 0
  buffer_load_dwordx4 v14, s[44:47], s73 offen lds
  buffer_load_dwordx4 v14, s[44:47], s73 offen offset:1024 lds
  s_waitcnt vmcnt(14)
  s_add_u32 s73, s75, 3
  s_and_b32 s73, s73, 7
  s_lshl_b32 s73, s73, 13
  s_add_u32 s73, s73, 65536
  s_add_u32 m0, s72, 122880
  s_nop 0
  buffer_load_dwordx4 v14, s[44:47], s73 offen lds
  buffer_load_dwordx4 v14, s[44:47], s73 offen offset:1024 lds
  s_barrier
  s_barrier
  s_barrier
  s_barrier
  s_waitcnt vmcnt(14)
  s_add_u32 s73, s75, 4
  s_and_b32 s73, s73, 7
  s_lshl_b32 s73, s73, 13
  s_add_u32 m0, s72, 131072
  s_nop 0
  buffer_load_dwordx4 v14, s[44:47], s73 offen lds
  buffer_load_dwordx4 v14, s[44:47], s73 offen offset:1024 lds
  s_waitcnt vmcnt(14)
  s_add_u32 s73, s75, 4
  s_and_b32 s73, s73, 7
  s_lshl_b32 s73, s73, 13
  s_add_u32 s73, s73, 65536
  s_add_u32 m0, s72, 139264
  s_nop 0
  buffer_load_dwordx4 v14, s[44:47], s73 offen lds
  buffer_load_dwordx4 v14, s[44:47], s73 offen offset:1024 lds
  s_barrier
  s_waitcnt vmcnt(14)
  s_add_u32 s73, s75, 5
  s_and_b32 s73, s73, 7
  s_lshl_b32 s73, s73, 13
  s_add_u32 m0, s72, 147456
  s_nop 0
  buffer_load_dwordx4 v14, s[44:47], s73 offen lds
  buffer_load_dwordx4 v14, s[44:47], s73 offen offset:1024 lds
  s_waitcnt vmcnt(14)
  s_add_u32 s73, s75, 5
  s_and_b32 s73, s73, 7
  s_lshl_b32 s73, s73, 13
  s_add_u32 s73, s73, 65536
  s_add_u32 m0, s72, 155648
  s_nop 0
  buffer_load_dwordx4 v14, s[44:47], s73 offen lds
  buffer_load_dwordx4 v14, s[44:47], s73 offen offset:1024 lds
  s_barrier
  s_waitcnt vmcnt(14)
  s_add_u32 s73, s75, 6
  s_and_b32 s73, s73, 7
  s_lshl_b32 s73, s73, 13
  s_add_u32 m0, s72, 32768
  s_nop 0
  buffer_load_dwordx4 v14, s[44:47], s73 offen lds
  buffer_load_dwordx4 v14, s[44:47], s73 offen offset:1024 lds
  s_waitcnt vmcnt(14)
  s_add_u32 s73, s75, 6
  s_and_b32 s73, s73, 7
  s_lshl_b32 s73, s73, 13
  s_add_u32 s73, s73, 65536
  s_add_u32 m0, s72, 40960
  s_nop 0
  buffer_load_dwordx4 v14, s[44:47], s73 offen lds
  buffer_load_dwordx4 v14, s[44:47], s73 offen offset:1024 lds
  s_barrier
  s_waitcnt vmcnt(14)
  s_add_u32 s73, s75, 7
  s_and_b32 s73, s73, 7
  s_lshl_b32 s73, s73, 13
  s_add_u32 m0, s72, 49152
  s_nop 0
  buffer_load_dwordx4 v14, s[44:47], s73 offen lds
  buffer_load_dwordx4 v14, s[44:47], s73 offen offset:1024 lds
  s_waitcnt vmcnt(14)
  s_add_u32 s73, s75, 7
  s_and_b32 s73, s73, 7
  s_lshl_b32 s73, s73, 13
  s_add_u32 s73, s73, 65536
  s_add_u32 m0, s72, 57344
  s_nop 0
  buffer_load_dwordx4 v14, s[44:47], s73 offen lds
  buffer_load_dwordx4 v14, s[44:47], s73 offen offset:1024 lds
  s_barrier
  s_waitcnt vmcnt(14)
  s_add_u32 s73, s76, 0
  s_and_b32 s73, s73, 15
  s_lshl_b32 s73, s73, 17
  s_add_u32 m0, s72, 65536
  s_nop 0
  buffer_load_dwordx4 v16, s[56:59], s73 offen lds
  buffer_load_dwordx4 v17, s[56:59], s73 offen offset:1024 lds
  s_waitcnt vmcnt(14)
  s_add_u32 s73, s76, 0
  s_and_b32 s73, s73, 15
  s_lshl_b32 s73, s73, 17
  s_add_u32 s73, s73, 65536
  s_add_u32 m0, s72, 73728
  s_nop 0
  buffer_load_dwordx4 v16, s[56:59], s73 offen lds
  buffer_load_dwordx4 v17, s[56:59], s73 offen offset:1024 lds
  s_waitcnt vmcnt(14)
  s_add_u32 s73, s76, 1
  s_and_b32 s73, s73, 15
  s_lshl_b32 s73, s73, 17
  s_add_u32 m0, s72, 81920
  s_nop 0
  buffer_load_dwordx4 v16, s[56:59], s73 offen lds
  buffer_load_dwordx4 v17, s[56:59], s73 offen offset:1024 lds
  s_waitcnt vmcnt(14)
  s_add_u32 s73, s76, 1
  s_and_b32 s73, s73, 15
  s_lshl_b32 s73, s73, 17
  s_add_u32 s73, s73, 65536
  s_add_u32 m0, s72, 90112
  s_nop 0
  buffer_load_dwordx4 v16, s[56:59], s73 offen lds
  buffer_load_dwordx4 v17, s[56:59], s73 offen offset:1024 lds
  s_barrier
  s_barrier
  s_waitcnt vmcnt(14)
  s_add_u32 s73, s76, 2
  s_and_b32 s73, s73, 15
  s_lshl_b32 s73, s73, 17
  s_add_u32 m0, s72, 98304
  s_nop 0
  buffer_load_dwordx4 v16, s[56:59], s73 offen lds
  buffer_load_dwordx4 v17, s[56:59], s73 offen offset:1024 lds
  s_waitcnt vmcnt(14)
  s_add_u32 s73, s76, 2
  s_and_b32 s73, s73, 15
  s_lshl_b32 s73, s73, 17
  s_add_u32 s73, s73, 65536
  s_add_u32 m0, s72, 106496
  s_nop 0
  buffer_load_dwordx4 v16, s[56:59], s73 offen lds
  buffer_load_dwordx4 v17, s[56:59], s73 offen offset:1024 lds
  s_waitcnt vmcnt(14)
  s_add_u32 s73, s76, 3
  s_and_b32 s73, s73, 15
  s_lshl_b32 s73, s73, 17
  s_add_u32 m0, s72, 114688
  s_nop 0
  buffer_load_dwordx4 v16, s[56:59], s73 offen lds
  buffer_load_dwordx4 v17, s[56:59], s73 offen offset:1024 lds
  s_waitcnt vmcnt(14)
  s_add_u32 s73, s76, 3
  s_and_b32 s73, s73, 15
  s_lshl_b32 s73, s73, 17
  s_add_u32 s73, s73, 65536
  s_add_u32 m0, s72, 122880
  s_nop 0
  buffer_load_dwordx4 v16, s[56:59], s73 offen lds
  buffer_load_dwordx4 v17, s[56:59], s73 offen offset:1024 lds
  s_barrier
  s_barrier
  s_barrier
  s_barrier
  s_waitcnt vmcnt(10)
  s_add_u32 s73, s76, 4
  s_and_b32 s73, s73, 15
  s_lshl_b32 s73, s73, 17
  s_add_u32 m0, s72, 131072
  s_nop 0
  buffer_load_dwordx4 v16, s[56:59], s73 offen lds
  buffer_load_dwordx4 v17, s[56:59], s73 offen offset:1024 lds
  s_waitcnt vmcnt(10)
  s_add_u32 s73, s76, 4
  s_and_b32 s73, s73, 15
  s_lshl_b32 s73, s73, 17
  s_add_u32 s73, s73, 65536
  s_add_u32 m0, s72, 139264
  s_nop 0
  buffer_load_dwordx4 v16, s[56:59], s73 offen lds
  buffer_load_dwordx4 v17, s[56:59], s73 offen offset:1024 lds
  s_waitcnt vmcnt(10)
  s_add_u32 s73, s76, 5
  s_and_b32 s73, s73, 15
  s_lshl_b32 s73, s73, 17
  s_add_u32 m0, s72, 147456
  s_nop 0
  buffer_load_dwordx4 v16, s[56:59], s73 offen lds
  buffer_load_dwordx4 v17, s[56:59], s73 offen offset:1024 lds
  s_waitcnt vmcnt(10)
  s_add_u32 s73, s76, 5
  s_and_b32 s73, s73, 15
  s_lshl_b32 s73, s73, 17
  s_add_u32 s73, s73, 65536
  s_add_u32 m0, s72, 155648
  s_nop 0
  buffer_load_dwordx4 v16, s[56:59], s73 offen lds
  buffer_load_dwordx4 v17, s[56:59], s73 offen offset:1024 lds
  s_barrier
  s_waitcnt vmcnt(10)
  s_add_u32 s73, s76, 6
  s_and_b32 s73, s73, 15
  s_lshl_b32 s73, s73, 17
  s_add_u32 m0, s72, 32768
  s_nop 0
  buffer_load_dwordx4 v16, s[56:59], s73 offen lds
  buffer_load_dwordx4 v17, s[56:59], s73 offen offset:1024 lds
  s_waitcnt vmcnt(10)
  s_add_u32 s73, s76, 6
  s_and_b32 s73, s73, 15
  s_lshl_b32 s73, s73, 17
  s_add_u32 s73, s73, 65536
  s_add_u32 m0, s72, 40960
  s_nop 0
  buffer_load_dwordx4 v16, s[56:59], s73 offen lds
  buffer_load_dwordx4 v17, s[56:59], s73 offen offset:1024 lds
  s_waitcnt vmcnt(10)
  s_add_u32 s73, s76, 7
  s_and_b32 s73, s73, 15
  s_lshl_b32 s73, s73, 17
  s_add_u32 m0, s72, 49152
  s_nop 0
  buffer_load_dwordx4 v16, s[56:59], s73 offen lds
  buffer_load_dwordx4 v17, s[56:59], s73 offen offset:1024 lds
  s_waitcnt vmcnt(10)
  s_add_u32 s73, s76, 7
  s_and_b32 s73, s73, 15
  s_lshl_b32 s73, s73, 17
  s_add_u32 s73, s73, 65536
  s_add_u32 m0, s72, 57344
  s_nop 0
  buffer_load_dwordx4 v16, s[56:59], s73 offen lds
  buffer_load_dwordx4 v17, s[56:59], s73 offen offset:1024 lds
  s_barrier
  s_add_u32 s73, s76, 0
  s_and_b32 s73, s73, 15
  s_lshl_b32 s73, s73, 12
  s_add_u32 m0, s72, 0
  s_nop 0
  buffer_load_dwordx4 v15, s[52:55], s73 offen sc1 lds
  buffer_load_dwordx4 v15, s[52:55], s73 offen offset:1024 sc1 lds
  s_add_u32 s73, s76, 1
  s_and_b32 s73, s73, 15
  s_lshl_b32 s73, s73, 12
  s_add_u32 m0, s72, 8192
  s_nop 0
  buffer_load_dwordx4 v15, s[52:55], s73 offen sc1 lds
  buffer_load_dwordx4 v15, s[52:55], s73 offen offset:1024 sc1 lds
  s_waitcnt vmcnt(14)
  s_add_u32 s73, s76, 2
  s_and_b32 s73, s73, 15
  s_lshl_b32 s73, s73, 12
  s_add_u32 m0, s72, 16384
  s_nop 0
  buffer_load_dwordx4 v15, s[52:55], s73 offen sc1 lds
  buffer_load_dwordx4 v15, s[52:55], s73 offen offset:1024 sc1 lds
  s_waitcnt vmcnt(14)
  s_add_u32 s73, s76, 3
  s_and_b32 s73, s73, 15
  s_lshl_b32 s73, s73, 12
  s_add_u32 m0, s72, 24576
  s_nop 0
  buffer_load_dwordx4 v15, s[52:55], s73 offen sc1 lds
  buffer_load_dwordx4 v15, s[52:55], s73 offen offset:1024 sc1 lds
  s_waitcnt vmcnt(6)
  s_barrier
  s_waitcnt vmcnt(4)
  s_barrier
  s_add_u32 s73, s76, 4
  s_and_b32 s73, s73, 15
  s_lshl_b32 s73, s73, 12
  s_add_u32 m0, s72, 0
  s_nop 0
  buffer_load_dwordx4 v15, s[52:55], s73 offen sc1 lds
  buffer_load_dwordx4 v15, s[52:55], s73 offen offset:1024 sc1 lds
  s_add_u32 s73, s76, 8
  s_and_b32 s73, s73, 15
  s_lshl_b32 s73, s73, 17
  s_add_u32 m0, s72, 65536
  s_nop 0
  buffer_load_dwordx4 v16, s[56:59], s73 offen lds
  buffer_load_dwordx4 v17, s[56:59], s73 offen offset:1024 lds
  s_add_u32 s73, s76, 8
  s_and_b32 s73, s73, 15
  s_lshl_b32 s73, s73, 17
  s_add_u32 s73, s73, 65536
  s_add_u32 m0, s72, 73728
  s_nop 0
  buffer_load_dwordx4 v16, s[56:59], s73 offen lds
  buffer_load_dwordx4 v17, s[56:59], s73 offen offset:1024 lds
  s_waitcnt vmcnt(8)
  s_barrier
  s_add_u32 s73, s76, 5
  s_and_b32 s73, s73, 15
  s_lshl_b32 s73, s73, 12
  s_add_u32 m0, s72, 8192
  s_nop 0
  buffer_load_dwordx4 v15, s[52:55], s73 offen sc1 lds
  buffer_load_dwordx4 v15, s[52:55], s73 offen offset:1024 sc1 lds
  s_add_u32 s73, s76, 9
  s_and_b32 s73, s73, 15
  s_lshl_b32 s73, s73, 17
  s_add_u32 m0, s72, 81920
  s_nop 0
  buffer_load_dwordx4 v16, s[56:59], s73 offen lds
  buffer_load_dwordx4 v17, s[56:59], s73 offen offset:1024 lds
  s_add_u32 s73, s76, 9
  s_and_b32 s73, s73, 15
  s_lshl_b32 s73, s73, 17
  s_add_u32 s73, s73, 65536
  s_add_u32 m0, s72, 90112
  s_nop 0
  buffer_load_dwordx4 v16, s[56:59], s73 offen lds
  buffer_load_dwordx4 v17, s[56:59], s73 offen offset:1024 lds
  s_waitcnt vmcnt(12)
  s_barrier
  s_add_u32 s73, s76, 6
  s_and_b32 s73, s73, 15
  s_lshl_b32 s73, s73, 12
  s_add_u32 m0, s72, 16384
  s_nop 0
  buffer_load_dwordx4 v15, s[52:55], s73 offen sc1 lds
  buffer_load_dwordx4 v15, s[52:55], s73 offen offset:1024 sc1 lds
  s_add_u32 s73, s76, 10
  s_and_b32 s73, s73, 15
  s_lshl_b32 s73, s73, 17
  s_add_u32 m0, s72, 98304
  s_nop 0
  buffer_load_dwordx4 v16, s[56:59], s73 offen lds
  buffer_load_dwordx4 v17, s[56:59], s73 offen offset:1024 lds
  s_waitcnt vmcnt(14)
  s_add_u32 s73, s76, 10
  s_and_b32 s73, s73, 15
  s_lshl_b32 s73, s73, 17
  s_add_u32 s73, s73, 65536
  s_add_u32 m0, s72, 106496
  s_nop 0
  buffer_load_dwordx4 v16, s[56:59], s73 offen lds
  buffer_load_dwordx4 v17, s[56:59], s73 offen offset:1024 lds
  s_barrier
  s_waitcnt vmcnt(14)
  s_add_u32 s73, s76, 7
  s_and_b32 s73, s73, 15
  s_lshl_b32 s73, s73, 12
  s_add_u32 m0, s72, 24576
  s_nop 0
  buffer_load_dwordx4 v15, s[52:55], s73 offen sc1 lds
  buffer_load_dwordx4 v15, s[52:55], s73 offen offset:1024 sc1 lds
  s_waitcnt vmcnt(14)
  s_add_u32 s73, s76, 11
  s_and_b32 s73, s73, 15
  s_lshl_b32 s73, s73, 17
  s_add_u32 m0, s72, 114688
  s_nop 0
  buffer_load_dwordx4 v16, s[56:59], s73 offen lds
  buffer_load_dwordx4 v17, s[56:59], s73 offen offset:1024 lds
  s_waitcnt vmcnt(14)
  s_add_u32 s73, s76, 11
  s_and_b32 s73, s73, 15
  s_lshl_b32 s73, s73, 17
  s_add_u32 s73, s73, 65536
  s_add_u32 m0, s72, 122880
  s_nop 0
  buffer_load_dwordx4 v16, s[56:59], s73 offen lds
  buffer_load_dwordx4 v17, s[56:59], s73 offen offset:1024 lds
  s_barrier
  s_waitcnt vmcnt(14)
  s_add_u32 s73, s76, 8
  s_and_b32 s73, s73, 15
  s_lshl_b32 s73, s73, 12
  s_add_u32 m0, s72, 0
  s_nop 0
  buffer_load_dwordx4 v15, s[52:55], s73 offen sc1 lds
  buffer_load_dwordx4 v15, s[52:55], s73 offen offset:1024 sc1 lds
  s_waitcnt vmcnt(14)
  s_add_u32 s73, s76, 12
  s_and_b32 s73, s73, 15
  s_lshl_b32 s73, s73, 17
  s_add_u32 m0, s72, 131072
  s_nop 0
  buffer_load_dwordx4 v16, s[56:59], s73 offen lds
  buffer_load_dwordx4 v17, s[56:59], s73 offen offset:1024 lds
  s_waitcnt vmcnt(14)
  s_add_u32 s73, s76, 12
  s_and_b32 s73, s73, 15
  s_lshl_b32 s73, s73, 17
  s_add_u32 s73, s73, 65536
  s_add_u32 m0, s72, 139264
  s_nop 0
  buffer_load_dwordx4 v16, s[56:59], s73 offen lds
  buffer_load_dwordx4 v17, s[56:59], s73 offen offset:1024 lds
  s_barrier
  s_waitcnt vmcnt(14)
  s_add_u32 s73, s76, 9
  s_and_b32 s73, s73, 15
  s_lshl_b32 s73, s73, 12
  s_add_u32 m0, s72, 8192
  s_nop 0
  buffer_load_dwordx4 v15, s[52:55], s73 offen sc1 lds
  buffer_load_dwordx4 v15, s[52:55], s73 offen offset:1024 sc1 lds
  s_waitcnt vmcnt(14)
  s_add_u32 s73, s76, 13
  s_and_b32 s73, s73, 15
  s_lshl_b32 s73, s73, 17
  s_add_u32 m0, s72, 147456
  s_nop 0
  buffer_load_dwordx4 v16, s[56:59], s73 offen lds
  buffer_load_dwordx4 v17, s[56:59], s73 offen offset:1024 lds
  s_waitcnt vmcnt(14)
  s_add_u32 s73, s76, 13
  s_and_b32 s73, s73, 15
  s_lshl_b32 s73, s73, 17
  s_add_u32 s73, s73, 65536
  s_add_u32 m0, s72, 155648
  s_nop 0
  buffer_load_dwordx4 v16, s[56:59], s73 offen lds
  buffer_load_dwordx4 v17, s[56:59], s73 offen offset:1024 lds
  s_barrier
  s_waitcnt vmcnt(14)
  s_add_u32 s73, s76, 10
  s_and_b32 s73, s73, 15
  s_lshl_b32 s73, s73, 12
  s_add_u32 m0, s72, 16384
  s_nop 0
  buffer_load_dwordx4 v15, s[52:55], s73 offen sc1 lds
  buffer_load_dwordx4 v15, s[52:55], s73 offen offset:1024 sc1 lds
  s_waitcnt vmcnt(14)
  s_add_u32 s73, s76, 14
  s_and_b32 s73, s73, 15
  s_lshl_b32 s73, s73, 17
  s_add_u32 m0, s72, 32768
  s_nop 0
  buffer_load_dwordx4 v16, s[56:59], s73 offen lds
  buffer_load_dwordx4 v17, s[56:59], s73 offen offset:1024 lds
  s_waitcnt vmcnt(14)
  s_add_u32 s73, s76, 14
  s_and_b32 s73, s73, 15
  s_lshl_b32 s73, s73, 17
  s_add_u32 s73, s73, 65536
  s_add_u32 m0, s72, 40960
  s_nop 0
  buffer_load_dwordx4 v16, s[56:59], s73 offen lds
  buffer_load_dwordx4 v17, s[56:59], s73 offen offset:1024 lds
  s_barrier
  s_waitcnt vmcnt(14)
  s_add_u32 s73, s76, 11
  s_and_b32 s73, s73, 15
  s_lshl_b32 s73, s73, 12
  s_add_u32 m0, s72, 24576
  s_nop 0
  buffer_load_dwordx4 v15, s[52:55], s73 offen sc1 lds
  buffer_load_dwordx4 v15, s[52:55], s73 offen offset:1024 sc1 lds
  s_waitcnt vmcnt(14)
  s_add_u32 s73, s76, 15
  s_and_b32 s73, s73, 15
  s_lshl_b32 s73, s73, 17
  s_add_u32 m0, s72, 49152
  s_nop 0
  buffer_load_dwordx4 v16, s[56:59], s73 offen lds
  buffer_load_dwordx4 v17, s[56:59], s73 offen offset:1024 lds
  s_waitcnt vmcnt(14)
  s_add_u32 s73, s76, 15
  s_and_b32 s73, s73, 15
  s_lshl_b32 s73, s73, 17
  s_add_u32 s73, s73, 65536
  s_add_u32 m0, s72, 57344
  s_nop 0
  buffer_load_dwordx4 v16, s[56:59], s73 offen lds
  buffer_load_dwordx4 v17, s[56:59], s73 offen offset:1024 lds
  s_barrier
  s_waitcnt vmcnt(14)
  s_add_u32 s73, s76, 12
  s_and_b32 s73, s73, 15
  s_lshl_b32 s73, s73, 12
  s_add_u32 m0, s72, 0
  s_nop 0
  buffer_load_dwordx4 v15, s[52:55], s73 offen sc1 lds
  buffer_load_dwordx4 v15, s[52:55], s73 offen offset:1024 sc1 lds
  s_waitcnt vmcnt(12)
  s_barrier
  s_add_u32 s73, s76, 13
  s_and_b32 s73, s73, 15
  s_lshl_b32 s73, s73, 12
  s_add_u32 m0, s72, 8192
  s_nop 0
  buffer_load_dwordx4 v15, s[52:55], s73 offen sc1 lds
  buffer_load_dwordx4 v15, s[52:55], s73 offen offset:1024 sc1 lds
  s_waitcnt vmcnt(8)
  s_barrier
  s_add_u32 s73, s76, 14
  s_and_b32 s73, s73, 15
  s_lshl_b32 s73, s73, 12
  s_add_u32 m0, s72, 16384
  s_nop 0
  buffer_load_dwordx4 v15, s[52:55], s73 offen sc1 lds
  buffer_load_dwordx4 v15, s[52:55], s73 offen offset:1024 sc1 lds
  s_waitcnt vmcnt(4)
  s_barrier
  s_add_u32 s73, s76, 15
  s_and_b32 s73, s73, 15
  s_lshl_b32 s73, s73, 12
  s_add_u32 m0, s72, 24576
  s_nop 0
  buffer_load_dwordx4 v15, s[52:55], s73 offen sc1 lds
  buffer_load_dwordx4 v15, s[52:55], s73 offen offset:1024 sc1 lds
  s_waitcnt vmcnt(4)
  s_barrier
  s_waitcnt vmcnt(2)
  s_barrier
  s_waitcnt vmcnt(0)
  s_barrier
  s_endpgm
standalone__gqa_block_cached__near_ridge_kernel_compute_2:
  s_lshl_b32 s29, s21, 2
  s_add_u32 s29, s29, s20
  s_lshl_b32 s29, s29, 3
  s_add_u32 s29, s29, s22
  s_and_b32 s27, s23, 1
  s_lshr_b32 s28, s23, 1
  v_lshlrev_b32 v2, 4, v1
  v_and_b32 v3, 31, v1
  s_lshl_b32 s24, s27, 5
  v_add_u32 v3, s24, v3
  v_lshrrev_b32 v4, 1, v3
  v_and_b32 v4, 7, v4
  v_lshrrev_b32 v5, 5, v1
  v_xor_b32 v4, v4, v5
  v_lshlrev_b32 v3, 7, v3
  v_xor_b32 v6, 0, v4
  v_lshl_add_u32 v8, v6, 4, v3
  v_add_u32 v8, 0, v8
  v_xor_b32 v6, 2, v4
  v_lshl_add_u32 v9, v6, 4, v3
  v_add_u32 v9, 0, v9
  v_xor_b32 v6, 4, v4
  v_lshl_add_u32 v10, v6, 4, v3
  v_add_u32 v10, 0, v10
  v_xor_b32 v6, 6, v4
  v_lshl_add_u32 v11, v6, 4, v3
  v_add_u32 v11, 0, v11
  s_lshl_b32 s75, s28, 3
  s_add_u32 s76, s75, 4
  v_and_b32 v3, 15, v1
  v_lshrrev_b32 v4, 2, v3
  v_lshrrev_b32 v5, 5, v1
  v_lshl_add_u32 v5, v5, 3, v4
  v_lshlrev_b32 v5, 8, v5
  v_bfe_u32 v7, v3, 1, 1
  v_lshl_add_u32 v5, v7, 3, v5
  v_and_b32 v6, 1, v3
  v_bfe_u32 v7, v1, 4, 1
  v_lshl_add_u32 v6, v7, 1, v6
  v_lshlrev_b32 v4, 2, v4
  v_add_u32 v7, s75, v6
  v_xor_b32 v7, v7, v4
  v_lshl_add_u32 v12, v7, 4, v5
  v_add_u32 v7, s76, v6
  v_xor_b32 v7, v7, v4
  v_lshl_add_u32 v13, v7, 4, v5
  v_add_u32 v14, 65536, v12
  v_add_u32 v15, 65536, v13
  v_mov_b32 v16, 0
  v_mov_b32 v17, 0
  v_mov_b32 v18, 0
  v_mov_b32 v19, 0
  v_mov_b32 v20, 0
  v_mov_b32 v21, 0
  v_mov_b32 v22, 0
  v_mov_b32 v23, 0
  v_mov_b32 v24, 0
  v_mov_b32 v25, 0
  v_mov_b32 v26, 0
  v_mov_b32 v27, 0
  v_mov_b32 v28, 0
  v_mov_b32 v29, 0
  v_mov_b32 v30, 0
  v_mov_b32 v31, 0
  v_mov_b32 v32, 0
  v_mov_b32 v33, 0
  v_mov_b32 v34, 0
  v_mov_b32 v35, 0
  v_mov_b32 v36, 0
  v_mov_b32 v37, 0
  v_mov_b32 v38, 0
  v_mov_b32 v39, 0
  v_mov_b32 v40, 0
  v_mov_b32 v41, 0
  v_mov_b32 v42, 0
  v_mov_b32 v43, 0
  v_mov_b32 v44, 0
  v_mov_b32 v45, 0
  v_mov_b32 v46, 0
  v_mov_b32 v47, 0
  s_waitcnt lgkmcnt(0)
  s_mov_b32 s24, 16777216
  s_add_u32 s68, s18, s24
  s_addc_u32 s69, s19, 0
  s_mov_b32 s70, 1052672
  s_mov_b32 s71, 0x20000
  v_mov_b32 v61, 0
  s_lshl_b32 s74, s21, 7
  s_add_u32 s74, s74, 1048576
  buffer_load_dword v62, v61, s[68:71], s74 offen sc1
  s_cmp_eq_u32 s23, 1
  s_cbranch_scc1 standalone__gqa_block_cached__near_ridge_kernel_warm1_4
  s_cmp_eq_u32 s23, 2
  s_cbranch_scc1 standalone__gqa_block_cached__near_ridge_kernel_warm2_5
  s_cmp_eq_u32 s23, 3
  s_cbranch_scc1 standalone__gqa_block_cached__near_ridge_kernel_warm3_6
standalone__gqa_block_cached__near_ridge_kernel_warm0_3:
  s_and_b32 s24, s22, 1
  s_lshl_b32 s25, s21, 1
  s_add_u32 s24, s24, s25
  s_lshl_b32 s24, s24, 2
  s_add_u32 s24, s24, s20
  s_lshl_b32 s24, s24, 17
  s_add_u32 s32, s6, s24
  s_addc_u32 s33, s7, 0
  s_mov_b32 s34, 4096
  s_mov_b32 s35, 0x20000
  s_mov_b64 exec, 1
  buffer_load_dword v58, v61, s[32:35], 0 offen
  s_mov_b64 exec, -1
  s_lshl_b32 s24, s20, 21
  s_add_u32 s24, s24, 0
  s_add_u32 s32, s12, s24
  s_addc_u32 s33, s13, 0
  s_mov_b32 s34, 4096
  s_mov_b32 s35, 0x20000
  s_mov_b64 exec, 1
  buffer_load_dword v58, v61, s[32:35], 0 offen
  s_mov_b64 exec, -1
  s_lshl_b32 s24, s21, 19
  s_add_u32 s24, s24, 0
  s_add_u32 s32, s18, s24
  s_addc_u32 s33, s19, 0
  s_mov_b32 s34, 4096
  s_mov_b32 s35, 0x20000
  s_mov_b64 exec, 1
  buffer_load_dword v58, v61, s[32:35], 0 offen
  s_mov_b64 exec, -1
  s_branch standalone__gqa_block_cached__near_ridge_kernel_warmend_7
standalone__gqa_block_cached__near_ridge_kernel_warm1_4:
  s_and_b32 s24, s22, 1
  s_lshl_b32 s25, s21, 1
  s_add_u32 s24, s24, s25
  s_lshl_b32 s24, s24, 2
  s_add_u32 s24, s24, s20
  s_lshl_b32 s24, s24, 17
  s_add_u32 s32, s8, s24
  s_addc_u32 s33, s9, 0
  s_mov_b32 s34, 4096
  s_mov_b32 s35, 0x20000
  s_mov_b64 exec, 1
  buffer_load_dword v58, v61, s[32:35], 0 offen
  s_mov_b64 exec, -1
  s_lshl_b32 s24, s20, 21
  s_add_u32 s24, s24, 1048576
  s_add_u32 s32, s12, s24
  s_addc_u32 s33, s13, 0
  s_mov_b32 s34, 4096
  s_mov_b32 s35, 0x20000
  s_mov_b64 exec, 1
  buffer_load_dword v58, v61, s[32:35], 0 offen
  s_mov_b64 exec, -1
  s_lshl_b32 s24, s21, 19
  s_add_u32 s24, s24, 4194304
  s_add_u32 s32, s18, s24
  s_addc_u32 s33, s19, 0
  s_mov_b32 s34, 4096
  s_mov_b32 s35, 0x20000
  s_mov_b64 exec, 1
  buffer_load_dword v58, v61, s[32:35], 0 offen
  s_mov_b64 exec, -1
  s_branch standalone__gqa_block_cached__near_ridge_kernel_warmend_7
standalone__gqa_block_cached__near_ridge_kernel_warm2_5:
  s_lshl_b32 s24, s21, 20
  s_add_u32 s24, s24, 8388608
  s_add_u32 s32, s18, s24
  s_addc_u32 s33, s19, 0
  s_mov_b32 s34, 4096
  s_mov_b32 s35, 0x20000
  s_mov_b64 exec, 1
  buffer_load_dword v58, v61, s[32:35], 0 offen
  s_mov_b64 exec, -1
  s_lshl_b32 s24, s21, 17
  s_add_u32 s32, s14, s24
  s_addc_u32 s33, s15, 0
  s_mov_b32 s34, 4096
  s_mov_b32 s35, 0x20000
  s_mov_b64 exec, 1
  buffer_load_dword v58, v61, s[32:35], 0 offen
  s_mov_b64 exec, -1
  s_branch standalone__gqa_block_cached__near_ridge_kernel_warmend_7
standalone__gqa_block_cached__near_ridge_kernel_warm3_6:
standalone__gqa_block_cached__near_ridge_kernel_warmend_7:
  s_barrier
  ds_read_b128 v[64:67], v8
  ds_read_b64_tr_b16 v[80:81], v12 offset:32768
  ds_read_b64_tr_b16 v[82:83], v12 offset:33792
  ds_read_b64_tr_b16 v[96:97], v13 offset:32768
  ds_read_b64_tr_b16 v[98:99], v13 offset:33792
  ds_read_b128 v[68:71], v9
  ds_read_b64_tr_b16 v[84:85], v12 offset:36864
  ds_read_b64_tr_b16 v[86:87], v12 offset:37888
  ds_read_b64_tr_b16 v[100:101], v13 offset:36864
  ds_read_b64_tr_b16 v[102:103], v13 offset:37888
  ds_read_b128 v[72:75], v10
  ds_read_b64_tr_b16 v[88:89], v12 offset:40960
  ds_read_b64_tr_b16 v[90:91], v12 offset:41984
  ds_read_b64_tr_b16 v[104:105], v13 offset:40960
  ds_read_b64_tr_b16 v[106:107], v13 offset:41984
  ds_read_b128 v[76:79], v11
  ds_read_b64_tr_b16 v[92:93], v12 offset:45056
  ds_read_b64_tr_b16 v[94:95], v12 offset:46080
  ds_read_b64_tr_b16 v[108:109], v13 offset:45056
  ds_read_b64_tr_b16 v[110:111], v13 offset:46080
  s_waitcnt lgkmcnt(0)
  s_barrier
  v_mfma_f32_32x32x16_bf16 v[16:31], v[80:83], v[64:67], v[16:31]
  ds_read_b128 v[112:115], v8 offset:8192
  ds_read_b64_tr_b16 v[128:129], v12 offset:49152
  ds_read_b64_tr_b16 v[130:131], v12 offset:50176
  ds_read_b64_tr_b16 v[144:145], v13 offset:49152
  v_mfma_f32_32x32x16_bf16 v[32:47], v[96:99], v[64:67], v[32:47]
  ds_read_b64_tr_b16 v[146:147], v13 offset:50176
  ds_read_b128 v[116:119], v9 offset:8192
  ds_read_b64_tr_b16 v[132:133], v12 offset:53248
  v_mfma_f32_32x32x16_bf16 v[16:31], v[84:87], v[68:71], v[16:31]
  ds_read_b64_tr_b16 v[134:135], v12 offset:54272
  ds_read_b64_tr_b16 v[148:149], v13 offset:53248
  ds_read_b64_tr_b16 v[150:151], v13 offset:54272
  v_mfma_f32_32x32x16_bf16 v[32:47], v[100:103], v[68:71], v[32:47]
  ds_read_b128 v[120:123], v10 offset:8192
  ds_read_b64_tr_b16 v[136:137], v12 offset:57344
  ds_read_b64_tr_b16 v[138:139], v12 offset:58368
  ds_read_b64_tr_b16 v[152:153], v13 offset:57344
  v_mfma_f32_32x32x16_bf16 v[16:31], v[88:91], v[72:75], v[16:31]
  ds_read_b64_tr_b16 v[154:155], v13 offset:58368
  ds_read_b128 v[124:127], v11 offset:8192
  ds_read_b64_tr_b16 v[140:141], v12 offset:61440
  v_mfma_f32_32x32x16_bf16 v[32:47], v[104:107], v[72:75], v[32:47]
  ds_read_b64_tr_b16 v[142:143], v12 offset:62464
  ds_read_b64_tr_b16 v[156:157], v13 offset:61440
  ds_read_b64_tr_b16 v[158:159], v13 offset:62464
  v_mfma_f32_32x32x16_bf16 v[16:31], v[92:95], v[76:79], v[16:31]
  v_mfma_f32_32x32x16_bf16 v[32:47], v[108:111], v[76:79], v[32:47]
  s_waitcnt lgkmcnt(0)
  s_waitcnt vmcnt(0)
  v_readfirstlane_b32 s82, v62
  s_nop 3
  s_add_u32 s82, s82, 2654435761
  s_getreg_b32 s9, hwreg(HW_REG_XCC_ID, 0, 4)
  s_add_u32 s9, s9, s82
  s_add_u32 s9, s9, 1
  s_mov_b32 s8, 0
  s_cmp_lg_u32 s23, 0
  s_cbranch_scc1 standalone__gqa_block_cached__near_ridge_kernel_nohello_8
  v_mov_b32 v62, s9
  s_lshl_b32 s24, s29, 7
  s_add_u32 s24, s24, 262144
  s_mov_b64 exec, 1
  buffer_store_dword v62, v61, s[68:71], s24 offen sc1
  s_mov_b64 exec, -1
standalone__gqa_block_cached__near_ridge_kernel_nohello_8:
  s_barrier
  v_mfma_f32_32x32x16_bf16 v[16:31], v[128:131], v[112:115], v[16:31]
  ds_read_b128 v[64:67], v8 offset:16384
  ds_read_b64_tr_b16 v[80:81], v14
  ds_read_b64_tr_b16 v[82:83], v14 offset:1024
  ds_read_b64_tr_b16 v[96:97], v15
  v_mfma_f32_32x32x16_bf16 v[32:47], v[144:147], v[112:115], v[32:47]
  ds_read_b64_tr_b16 v[98:99], v15 offset:1024
  ds_read_b128 v[68:71], v9 offset:16384
  ds_read_b64_tr_b16 v[84:85], v14 offset:4096
  v_mfma_f32_32x32x16_bf16 v[16:31], v[132:135], v[116:119], v[16:31]
  ds_read_b64_tr_b16 v[86:87], v14 offset:5120
  ds_read_b64_tr_b16 v[100:101], v15 offset:4096
  ds_read_b64_tr_b16 v[102:103], v15 offset:5120
  v_mfma_f32_32x32x16_bf16 v[32:47], v[148:151], v[116:119], v[32:47]
  ds_read_b128 v[72:75], v10 offset:16384
  ds_read_b64_tr_b16 v[88:89], v14 offset:8192
  ds_read_b64_tr_b16 v[90:91], v14 offset:9216
  ds_read_b64_tr_b16 v[104:105], v15 offset:8192
  v_mfma_f32_32x32x16_bf16 v[16:31], v[136:139], v[120:123], v[16:31]
  ds_read_b64_tr_b16 v[106:107], v15 offset:9216
  ds_read_b128 v[76:79], v11 offset:16384
  ds_read_b64_tr_b16 v[92:93], v14 offset:12288
  v_mfma_f32_32x32x16_bf16 v[32:47], v[152:155], v[120:123], v[32:47]
  ds_read_b64_tr_b16 v[94:95], v14 offset:13312
  ds_read_b64_tr_b16 v[108:109], v15 offset:12288
  ds_read_b64_tr_b16 v[110:111], v15 offset:13312
  v_mfma_f32_32x32x16_bf16 v[16:31], v[140:143], v[124:127], v[16:31]
  v_mfma_f32_32x32x16_bf16 v[32:47], v[156:159], v[124:127], v[32:47]
  s_waitcnt lgkmcnt(0)
  s_barrier
  v_mfma_f32_32x32x16_bf16 v[16:31], v[80:83], v[64:67], v[16:31]
  ds_read_b128 v[112:115], v8 offset:24576
  ds_read_b64_tr_b16 v[128:129], v14 offset:16384
  ds_read_b64_tr_b16 v[130:131], v14 offset:17408
  ds_read_b64_tr_b16 v[144:145], v15 offset:16384
  v_mfma_f32_32x32x16_bf16 v[32:47], v[96:99], v[64:67], v[32:47]
  ds_read_b64_tr_b16 v[146:147], v15 offset:17408
  ds_read_b128 v[116:119], v9 offset:24576
  ds_read_b64_tr_b16 v[132:133], v14 offset:20480
  v_mfma_f32_32x32x16_bf16 v[16:31], v[84:87], v[68:71], v[16:31]
  ds_read_b64_tr_b16 v[134:135], v14 offset:21504
  ds_read_b64_tr_b16 v[148:149], v15 offset:20480
  ds_read_b64_tr_b16 v[150:151], v15 offset:21504
  v_mfma_f32_32x32x16_bf16 v[32:47], v[100:103], v[68:71], v[32:47]
  ds_read_b128 v[120:123], v10 offset:24576
  ds_read_b64_tr_b16 v[136:137], v14 offset:24576
  ds_read_b64_tr_b16 v[138:139], v14 offset:25600
  ds_read_b64_tr_b16 v[152:153], v15 offset:24576
  v_mfma_f32_32x32x16_bf16 v[16:31], v[88:91], v[72:75], v[16:31]
  ds_read_b64_tr_b16 v[154:155], v15 offset:25600
  ds_read_b128 v[124:127], v11 offset:24576
  ds_read_b64_tr_b16 v[140:141], v14 offset:28672
  v_mfma_f32_32x32x16_bf16 v[32:47], v[104:107], v[72:75], v[32:47]
  ds_read_b64_tr_b16 v[142:143], v14 offset:29696
  ds_read_b64_tr_b16 v[156:157], v15 offset:28672
  ds_read_b64_tr_b16 v[158:159], v15 offset:29696
  v_mfma_f32_32x32x16_bf16 v[16:31], v[92:95], v[76:79], v[16:31]
  v_mfma_f32_32x32x16_bf16 v[32:47], v[108:111], v[76:79], v[32:47]
  s_waitcnt lgkmcnt(0)
  s_barrier
  v_mfma_f32_32x32x16_bf16 v[16:31], v[128:131], v[112:115], v[16:31]
  ds_read_b128 v[64:67], v8
  ds_read_b64_tr_b16 v[80:81], v12 offset:32768
  ds_read_b64_tr_b16 v[82:83], v12 offset:33792
  ds_read_b64_tr_b16 v[96:97], v13 offset:32768
  v_mfma_f32_32x32x16_bf16 v[32:47], v[144:147], v[112:115], v[32:47]
  ds_read_b64_tr_b16 v[98:99], v13 offset:33792
  ds_read_b128 v[68:71], v9
  ds_read_b64_tr_b16 v[84:85], v12 offset:36864
  v_mfma_f32_32x32x16_bf16 v[16:31], v[132:135], v[116:119], v[16:31]
  ds_read_b64_tr_b16 v[86:87], v12 offset:37888
  ds_read_b64_tr_b16 v[100:101], v13 offset:36864
  ds_read_b64_tr_b16 v[102:103], v13 offset:37888
  v_mfma_f32_32x32x16_bf16 v[32:47], v[148:151], v[116:119], v[32:47]
  ds_read_b128 v[72:75], v10
  ds_read_b64_tr_b16 v[88:89], v12 offset:40960
  ds_read_b64_tr_b16 v[90:91], v12 offset:41984
  ds_read_b64_tr_b16 v[104:105], v13 offset:40960
  v_mfma_f32_32x32x16_bf16 v[16:31], v[136:139], v[120:123], v[16:31]
  ds_read_b64_tr_b16 v[106:107], v13 offset:41984
  ds_read_b128 v[76:79], v11
  ds_read_b64_tr_b16 v[92:93], v12 offset:45056
  v_mfma_f32_32x32x16_bf16 v[32:47], v[152:155], v[120:123], v[32:47]
  ds_read_b64_tr_b16 v[94:95], v12 offset:46080
  ds_read_b64_tr_b16 v[108:109], v13 offset:45056
  ds_read_b64_tr_b16 v[110:111], v13 offset:46080
  v_mfma_f32_32x32x16_bf16 v[16:31], v[140:143], v[124:127], v[16:31]
  v_mfma_f32_32x32x16_bf16 v[32:47], v[156:159], v[124:127], v[32:47]
  s_waitcnt lgkmcnt(0)
  s_barrier
  v_mfma_f32_32x32x16_bf16 v[16:31], v[80:83], v[64:67], v[16:31]
  ds_read_b128 v[112:115], v8 offset:8192
  ds_read_b64_tr_b16 v[128:129], v12 offset:49152
  ds_read_b64_tr_b16 v[130:131], v12 offset:50176
  ds_read_b64_tr_b16 v[144:145], v13 offset:49152
  v_mfma_f32_32x32x16_bf16 v[32:47], v[96:99], v[64:67], v[32:47]
  ds_read_b64_tr_b16 v[146:147], v13 offset:50176
  ds_read_b128 v[116:119], v9 offset:8192
  ds_read_b64_tr_b16 v[132:133], v12 offset:53248
  v_mfma_f32_32x32x16_bf16 v[16:31], v[84:87], v[68:71], v[16:31]
  ds_read_b64_tr_b16 v[134:135], v12 offset:54272
  ds_read_b64_tr_b16 v[148:149], v13 offset:53248
  ds_read_b64_tr_b16 v[150:151], v13 offset:54272
  v_mfma_f32_32x32x16_bf16 v[32:47], v[100:103], v[68:71], v[32:47]
  ds_read_b128 v[120:123], v10 offset:8192
  ds_read_b64_tr_b16 v[136:137], v12 offset:57344
  ds_read_b64_tr_b16 v[138:139], v12 offset:58368
  ds_read_b64_tr_b16 v[152:153], v13 offset:57344
  v_mfma_f32_32x32x16_bf16 v[16:31], v[88:91], v[72:75], v[16:31]
  ds_read_b64_tr_b16 v[154:155], v13 offset:58368
  ds_read_b128 v[124:127], v11 offset:8192
  ds_read_b64_tr_b16 v[140:141], v12 offset:61440
  v_mfma_f32_32x32x16_bf16 v[32:47], v[104:107], v[72:75], v[32:47]
  ds_read_b64_tr_b16 v[142:143], v12 offset:62464
  ds_read_b64_tr_b16 v[156:157], v13 offset:61440
  ds_read_b64_tr_b16 v[158:159], v13 offset:62464
  v_mfma_f32_32x32x16_bf16 v[16:31], v[92:95], v[76:79], v[16:31]
  v_mfma_f32_32x32x16_bf16 v[32:47], v[108:111], v[76:79], v[32:47]
  s_waitcnt lgkmcnt(0)
  s_barrier
  v_mfma_f32_32x32x16_bf16 v[16:31], v[128:131], v[112:115], v[16:31]
  ds_read_b128 v[64:67], v8 offset:16384
  ds_read_b64_tr_b16 v[80:81], v14
  ds_read_b64_tr_b16 v[82:83], v14 offset:1024
  ds_read_b64_tr_b16 v[96:97], v15
  v_mfma_f32_32x32x16_bf16 v[32:47], v[144:147], v[112:115], v[32:47]
  ds_read_b64_tr_b16 v[98:99], v15 offset:1024
  ds_read_b128 v[68:71], v9 offset:16384
  ds_read_b64_tr_b16 v[84:85], v14 offset:4096
  v_mfma_f32_32x32x16_bf16 v[16:31], v[132:135], v[116:119], v[16:31]
  ds_read_b64_tr_b16 v[86:87], v14 offset:5120
  ds_read_b64_tr_b16 v[100:101], v15 offset:4096
  ds_read_b64_tr_b16 v[102:103], v15 offset:5120
  v_mfma_f32_32x32x16_bf16 v[32:47], v[148:151], v[116:119], v[32:47]
  ds_read_b128 v[72:75], v10 offset:16384
  ds_read_b64_tr_b16 v[88:89], v14 offset:8192
  ds_read_b64_tr_b16 v[90:91], v14 offset:9216
  ds_read_b64_tr_b16 v[104:105], v15 offset:8192
  v_mfma_f32_32x32x16_bf16 v[16:31], v[136:139], v[120:123], v[16:31]
  ds_read_b64_tr_b16 v[106:107], v15 offset:9216
  ds_read_b128 v[76:79], v11 offset:16384
  ds_read_b64_tr_b16 v[92:93], v14 offset:12288
  v_mfma_f32_32x32x16_bf16 v[32:47], v[152:155], v[120:123], v[32:47]
  ds_read_b64_tr_b16 v[94:95], v14 offset:13312
  ds_read_b64_tr_b16 v[108:109], v15 offset:12288
  ds_read_b64_tr_b16 v[110:111], v15 offset:13312
  v_mfma_f32_32x32x16_bf16 v[16:31], v[140:143], v[124:127], v[16:31]
  v_mfma_f32_32x32x16_bf16 v[32:47], v[156:159], v[124:127], v[32:47]
  s_waitcnt lgkmcnt(0)
  s_barrier
  v_mfma_f32_32x32x16_bf16 v[16:31], v[80:83], v[64:67], v[16:31]
  ds_read_b128 v[112:115], v8 offset:24576
  ds_read_b64_tr_b16 v[128:129], v14 offset:16384
  ds_read_b64_tr_b16 v[130:131], v14 offset:17408
  ds_read_b64_tr_b16 v[144:145], v15 offset:16384
  v_mfma_f32_32x32x16_bf16 v[32:47], v[96:99], v[64:67], v[32:47]
  ds_read_b64_tr_b16 v[146:147], v15 offset:17408
  ds_read_b128 v[116:119], v9 offset:24576
  ds_read_b64_tr_b16 v[132:133], v14 offset:20480
  v_mfma_f32_32x32x16_bf16 v[16:31], v[84:87], v[68:71], v[16:31]
  ds_read_b64_tr_b16 v[134:135], v14 offset:21504
  ds_read_b64_tr_b16 v[148:149], v15 offset:20480
  ds_read_b64_tr_b16 v[150:151], v15 offset:21504
  v_mfma_f32_32x32x16_bf16 v[32:47], v[100:103], v[68:71], v[32:47]
  ds_read_b128 v[120:123], v10 offset:24576
  ds_read_b64_tr_b16 v[136:137], v14 offset:24576
  ds_read_b64_tr_b16 v[138:139], v14 offset:25600
  ds_read_b64_tr_b16 v[152:153], v15 offset:24576
  v_mfma_f32_32x32x16_bf16 v[16:31], v[88:91], v[72:75], v[16:31]
  ds_read_b64_tr_b16 v[154:155], v15 offset:25600
  ds_read_b128 v[124:127], v11 offset:24576
  ds_read_b64_tr_b16 v[140:141], v14 offset:28672
  v_mfma_f32_32x32x16_bf16 v[32:47], v[104:107], v[72:75], v[32:47]
  ds_read_b64_tr_b16 v[142:143], v14 offset:29696
  ds_read_b64_tr_b16 v[156:157], v15 offset:28672
  ds_read_b64_tr_b16 v[158:159], v15 offset:29696
  v_mfma_f32_32x32x16_bf16 v[16:31], v[92:95], v[76:79], v[16:31]
  v_mfma_f32_32x32x16_bf16 v[32:47], v[108:111], v[76:79], v[32:47]
  s_waitcnt lgkmcnt(0)
  s_barrier
  s_and_b32 s24, s29, 248
  s_lshl_b32 s24, s24, 7
  s_add_u32 s24, s24, 262144
  v_lshlrev_b32 v58, 7, v1
  s_mov_b64 exec, 0xff
  buffer_load_dword v59, v58, s[68:71], s24 offen sc1
  s_mov_b64 exec, -1
  v_mfma_f32_32x32x16_bf16 v[16:31], v[128:131], v[112:115], v[16:31]
  ds_read_b128 v[64:67], v8
  ds_read_b64_tr_b16 v[80:81], v12 offset:32768
  ds_read_b64_tr_b16 v[82:83], v12 offset:33792
  ds_read_b64_tr_b16 v[96:97], v13 offset:32768
  v_mfma_f32_32x32x16_bf16 v[32:47], v[144:147], v[112:115], v[32:47]
  ds_read_b64_tr_b16 v[98:99], v13 offset:33792
  ds_read_b128 v[68:71], v9
  ds_read_b64_tr_b16 v[84:85], v12 offset:36864
  v_mfma_f32_32x32x16_bf16 v[16:31], v[132:135], v[116:119], v[16:31]
  ds_read_b64_tr_b16 v[86:87], v12 offset:37888
  ds_read_b64_tr_b16 v[100:101], v13 offset:36864
  ds_read_b64_tr_b16 v[102:103], v13 offset:37888
  v_mfma_f32_32x32x16_bf16 v[32:47], v[148:151], v[116:119], v[32:47]
  ds_read_b128 v[72:75], v10
  ds_read_b64_tr_b16 v[88:89], v12 offset:40960
  ds_read_b64_tr_b16 v[90:91], v12 offset:41984
  ds_read_b64_tr_b16 v[104:105], v13 offset:40960
  v_mfma_f32_32x32x16_bf16 v[16:31], v[136:139], v[120:123], v[16:31]
  ds_read_b64_tr_b16 v[106:107], v13 offset:41984
  ds_read_b128 v[76:79], v11
  ds_read_b64_tr_b16 v[92:93], v12 offset:45056
  v_mfma_f32_32x32x16_bf16 v[32:47], v[152:155], v[120:123], v[32:47]
  ds_read_b64_tr_b16 v[94:95], v12 offset:46080
  ds_read_b64_tr_b16 v[108:109], v13 offset:45056
  ds_read_b64_tr_b16 v[110:111], v13 offset:46080
  v_mfma_f32_32x32x16_bf16 v[16:31], v[140:143], v[124:127], v[16:31]
  v_mfma_f32_32x32x16_bf16 v[32:47], v[156:159], v[124:127], v[32:47]
  s_waitcnt lgkmcnt(0)
  s_barrier
  v_mfma_f32_32x32x16_bf16 v[16:31], v[80:83], v[64:67], v[16:31]
  ds_read_b128 v[112:115], v8 offset:8192
  ds_read_b64_tr_b16 v[128:129], v12 offset:49152
  ds_read_b64_tr_b16 v[130:131], v12 offset:50176
  ds_read_b64_tr_b16 v[144:145], v13 offset:49152
  v_mfma_f32_32x32x16_bf16 v[32:47], v[96:99], v[64:67], v[32:47]
  ds_read_b64_tr_b16 v[146:147], v13 offset:50176
  ds_read_b128 v[116:119], v9 offset:8192
  ds_read_b64_tr_b16 v[132:133], v12 offset:53248
  v_mfma_f32_32x32x16_bf16 v[16:31], v[84:87], v[68:71], v[16:31]
  ds_read_b64_tr_b16 v[134:135], v12 offset:54272
  ds_read_b64_tr_b16 v[148:149], v13 offset:53248
  ds_read_b64_tr_b16 v[150:151], v13 offset:54272
  v_mfma_f32_32x32x16_bf16 v[32:47], v[100:103], v[68:71], v[32:47]
  ds_read_b128 v[120:123], v10 offset:8192
  ds_read_b64_tr_b16 v[136:137], v12 offset:57344
  ds_read_b64_tr_b16 v[138:139], v12 offset:58368
  ds_read_b64_tr_b16 v[152:153], v13 offset:57344
  v_mfma_f32_32x32x16_bf16 v[16:31], v[88:91], v[72:75], v[16:31]
  ds_read_b64_tr_b16 v[154:155], v13 offset:58368
  ds_read_b128 v[124:127], v11 offset:8192
  ds_read_b64_tr_b16 v[140:141], v12 offset:61440
  v_mfma_f32_32x32x16_bf16 v[32:47], v[104:107], v[72:75], v[32:47]
  ds_read_b64_tr_b16 v[142:143], v12 offset:62464
  ds_read_b64_tr_b16 v[156:157], v13 offset:61440
  ds_read_b64_tr_b16 v[158:159], v13 offset:62464
  v_mfma_f32_32x32x16_bf16 v[16:31], v[92:95], v[76:79], v[16:31]
  v_mfma_f32_32x32x16_bf16 v[32:47], v[108:111], v[76:79], v[32:47]
  s_waitcnt lgkmcnt(0)
  s_barrier
  v_mfma_f32_32x32x16_bf16 v[16:31], v[128:131], v[112:115], v[16:31]
  ds_read_b128 v[64:67], v8 offset:16384
  ds_read_b64_tr_b16 v[80:81], v14
  ds_read_b64_tr_b16 v[82:83], v14 offset:1024
  ds_read_b64_tr_b16 v[96:97], v15
  v_mfma_f32_32x32x16_bf16 v[32:47], v[144:147], v[112:115], v[32:47]
  ds_read_b64_tr_b16 v[98:99], v15 offset:1024
  ds_read_b128 v[68:71], v9 offset:16384
  ds_read_b64_tr_b16 v[84:85], v14 offset:4096
  v_mfma_f32_32x32x16_bf16 v[16:31], v[132:135], v[116:119], v[16:31]
  ds_read_b64_tr_b16 v[86:87], v14 offset:5120
  ds_read_b64_tr_b16 v[100:101], v15 offset:4096
  ds_read_b64_tr_b16 v[102:103], v15 offset:5120
  v_mfma_f32_32x32x16_bf16 v[32:47], v[148:151], v[116:119], v[32:47]
  ds_read_b128 v[72:75], v10 offset:16384
  ds_read_b64_tr_b16 v[88:89], v14 offset:8192
  ds_read_b64_tr_b16 v[90:91], v14 offset:9216
  ds_read_b64_tr_b16 v[104:105], v15 offset:8192
  v_mfma_f32_32x32x16_bf16 v[16:31], v[136:139], v[120:123], v[16:31]
  ds_read_b64_tr_b16 v[106:107], v15 offset:9216
  ds_read_b128 v[76:79], v11 offset:16384
  ds_read_b64_tr_b16 v[92:93], v14 offset:12288
  v_mfma_f32_32x32x16_bf16 v[32:47], v[152:155], v[120:123], v[32:47]
  ds_read_b64_tr_b16 v[94:95], v14 offset:13312
  ds_read_b64_tr_b16 v[108:109], v15 offset:12288
  ds_read_b64_tr_b16 v[110:111], v15 offset:13312
  v_mfma_f32_32x32x16_bf16 v[16:31], v[140:143], v[124:127], v[16:31]
  v_mfma_f32_32x32x16_bf16 v[32:47], v[156:159], v[124:127], v[32:47]
  s_waitcnt lgkmcnt(0)
  s_barrier
  v_mfma_f32_32x32x16_bf16 v[16:31], v[80:83], v[64:67], v[16:31]
  ds_read_b128 v[112:115], v8 offset:24576
  ds_read_b64_tr_b16 v[128:129], v14 offset:16384
  ds_read_b64_tr_b16 v[130:131], v14 offset:17408
  ds_read_b64_tr_b16 v[144:145], v15 offset:16384
  v_mfma_f32_32x32x16_bf16 v[32:47], v[96:99], v[64:67], v[32:47]
  ds_read_b64_tr_b16 v[146:147], v15 offset:17408
  ds_read_b128 v[116:119], v9 offset:24576
  ds_read_b64_tr_b16 v[132:133], v14 offset:20480
  v_mfma_f32_32x32x16_bf16 v[16:31], v[84:87], v[68:71], v[16:31]
  ds_read_b64_tr_b16 v[134:135], v14 offset:21504
  ds_read_b64_tr_b16 v[148:149], v15 offset:20480
  ds_read_b64_tr_b16 v[150:151], v15 offset:21504
  v_mfma_f32_32x32x16_bf16 v[32:47], v[100:103], v[68:71], v[32:47]
  ds_read_b128 v[120:123], v10 offset:24576
  ds_read_b64_tr_b16 v[136:137], v14 offset:24576
  ds_read_b64_tr_b16 v[138:139], v14 offset:25600
  ds_read_b64_tr_b16 v[152:153], v15 offset:24576
  v_mfma_f32_32x32x16_bf16 v[16:31], v[88:91], v[72:75], v[16:31]
  ds_read_b64_tr_b16 v[154:155], v15 offset:25600
  ds_read_b128 v[124:127], v11 offset:24576
  ds_read_b64_tr_b16 v[140:141], v14 offset:28672
  v_mfma_f32_32x32x16_bf16 v[32:47], v[104:107], v[72:75], v[32:47]
  ds_read_b64_tr_b16 v[142:143], v14 offset:29696
  ds_read_b64_tr_b16 v[156:157], v15 offset:28672
  ds_read_b64_tr_b16 v[158:159], v15 offset:29696
  v_mfma_f32_32x32x16_bf16 v[16:31], v[92:95], v[76:79], v[16:31]
  v_mfma_f32_32x32x16_bf16 v[32:47], v[108:111], v[76:79], v[32:47]
  s_waitcnt lgkmcnt(0)
  s_barrier
  v_mfma_f32_32x32x16_bf16 v[16:31], v[128:131], v[112:115], v[16:31]
  ds_read_b128 v[64:67], v8
  ds_read_b64_tr_b16 v[80:81], v12 offset:32768
  ds_read_b64_tr_b16 v[82:83], v12 offset:33792
  ds_read_b64_tr_b16 v[96:97], v13 offset:32768
  v_mfma_f32_32x32x16_bf16 v[32:47], v[144:147], v[112:115], v[32:47]
  ds_read_b64_tr_b16 v[98:99], v13 offset:33792
  ds_read_b128 v[68:71], v9
  ds_read_b64_tr_b16 v[84:85], v12 offset:36864
  v_mfma_f32_32x32x16_bf16 v[16:31], v[132:135], v[116:119], v[16:31]
  ds_read_b64_tr_b16 v[86:87], v12 offset:37888
  ds_read_b64_tr_b16 v[100:101], v13 offset:36864
  ds_read_b64_tr_b16 v[102:103], v13 offset:37888
  v_mfma_f32_32x32x16_bf16 v[32:47], v[148:151], v[116:119], v[32:47]
  ds_read_b128 v[72:75], v10
  ds_read_b64_tr_b16 v[88:89], v12 offset:40960
  ds_read_b64_tr_b16 v[90:91], v12 offset:41984
  ds_read_b64_tr_b16 v[104:105], v13 offset:40960
  v_mfma_f32_32x32x16_bf16 v[16:31], v[136:139], v[120:123], v[16:31]
  ds_read_b64_tr_b16 v[106:107], v13 offset:41984
  ds_read_b128 v[76:79], v11
  ds_read_b64_tr_b16 v[92:93], v12 offset:45056
  v_mfma_f32_32x32x16_bf16 v[32:47], v[152:155], v[120:123], v[32:47]
  ds_read_b64_tr_b16 v[94:95], v12 offset:46080
  ds_read_b64_tr_b16 v[108:109], v13 offset:45056
  ds_read_b64_tr_b16 v[110:111], v13 offset:46080
  v_mfma_f32_32x32x16_bf16 v[16:31], v[140:143], v[124:127], v[16:31]
  v_mfma_f32_32x32x16_bf16 v[32:47], v[156:159], v[124:127], v[32:47]
  s_waitcnt lgkmcnt(0)
  s_barrier
  v_mfma_f32_32x32x16_bf16 v[16:31], v[80:83], v[64:67], v[16:31]
  ds_read_b128 v[112:115], v8 offset:8192
  ds_read_b64_tr_b16 v[128:129], v12 offset:49152
  ds_read_b64_tr_b16 v[130:131], v12 offset:50176
  ds_read_b64_tr_b16 v[144:145], v13 offset:49152
  v_mfma_f32_32x32x16_bf16 v[32:47], v[96:99], v[64:67], v[32:47]
  ds_read_b64_tr_b16 v[146:147], v13 offset:50176
  ds_read_b128 v[116:119], v9 offset:8192
  ds_read_b64_tr_b16 v[132:133], v12 offset:53248
  v_mfma_f32_32x32x16_bf16 v[16:31], v[84:87], v[68:71], v[16:31]
  ds_read_b64_tr_b16 v[134:135], v12 offset:54272
  ds_read_b64_tr_b16 v[148:149], v13 offset:53248
  ds_read_b64_tr_b16 v[150:151], v13 offset:54272
  v_mfma_f32_32x32x16_bf16 v[32:47], v[100:103], v[68:71], v[32:47]
  ds_read_b128 v[120:123], v10 offset:8192
  ds_read_b64_tr_b16 v[136:137], v12 offset:57344
  ds_read_b64_tr_b16 v[138:139], v12 offset:58368
  ds_read_b64_tr_b16 v[152:153], v13 offset:57344
  v_mfma_f32_32x32x16_bf16 v[16:31], v[88:91], v[72:75], v[16:31]
  ds_read_b64_tr_b16 v[154:155], v13 offset:58368
  ds_read_b128 v[124:127], v11 offset:8192
  ds_read_b64_tr_b16 v[140:141], v12 offset:61440
  v_mfma_f32_32x32x16_bf16 v[32:47], v[104:107], v[72:75], v[32:47]
  ds_read_b64_tr_b16 v[142:143], v12 offset:62464
  ds_read_b64_tr_b16 v[156:157], v13 offset:61440
  ds_read_b64_tr_b16 v[158:159], v13 offset:62464
  v_mfma_f32_32x32x16_bf16 v[16:31], v[92:95], v[76:79], v[16:31]
  v_mfma_f32_32x32x16_bf16 v[32:47], v[108:111], v[76:79], v[32:47]
  s_waitcnt lgkmcnt(0)
  s_waitcnt vmcnt(0)
  s_mov_b64 exec, 0xff
  v_cmp_eq_u32 vcc, s9, v59
  s_mov_b64 exec, -1
  s_nop 2
  s_cmp_eq_u64 vcc, 0xff
  s_cselect_b32 s8, 1, 0
  s_barrier
  v_mfma_f32_32x32x16_bf16 v[16:31], v[128:131], v[112:115], v[16:31]
  ds_read_b128 v[64:67], v8 offset:16384
  ds_read_b64_tr_b16 v[80:81], v14
  ds_read_b64_tr_b16 v[82:83], v14 offset:1024
  ds_read_b64_tr_b16 v[96:97], v15
  v_mfma_f32_32x32x16_bf16 v[32:47], v[144:147], v[112:115], v[32:47]
  ds_read_b64_tr_b16 v[98:99], v15 offset:1024
  ds_read_b128 v[68:71], v9 offset:16384
  ds_read_b64_tr_b16 v[84:85], v14 offset:4096
  v_mfma_f32_32x32x16_bf16 v[16:31], v[132:135], v[116:119], v[16:31]
  ds_read_b64_tr_b16 v[86:87], v14 offset:5120
  ds_read_b64_tr_b16 v[100:101], v15 offset:4096
  ds_read_b64_tr_b16 v[102:103], v15 offset:5120
  v_mfma_f32_32x32x16_bf16 v[32:47], v[148:151], v[116:119], v[32:47]
  ds_read_b128 v[72:75], v10 offset:16384
  ds_read_b64_tr_b16 v[88:89], v14 offset:8192
  ds_read_b64_tr_b16 v[90:91], v14 offset:9216
  ds_read_b64_tr_b16 v[104:105], v15 offset:8192
  v_mfma_f32_32x32x16_bf16 v[16:31], v[136:139], v[120:123], v[16:31]
  ds_read_b64_tr_b16 v[106:107], v15 offset:9216
  ds_read_b128 v[76:79], v11 offset:16384
  ds_read_b64_tr_b16 v[92:93], v14 offset:12288
  v_mfma_f32_32x32x16_bf16 v[32:47], v[152:155], v[120:123], v[32:47]
  ds_read_b64_tr_b16 v[94:95], v14 offset:13312
  ds_read_b64_tr_b16 v[108:109], v15 offset:12288
  ds_read_b64_tr_b16 v[110:111], v15 offset:13312
  v_mfma_f32_32x32x16_bf16 v[16:31], v[140:143], v[124:127], v[16:31]
  v_mfma_f32_32x32x16_bf16 v[32:47], v[156:159], v[124:127], v[32:47]
  s_waitcnt lgkmcnt(0)
  s_barrier
  v_mfma_f32_32x32x16_bf16 v[16:31], v[80:83], v[64:67], v[16:31]
  ds_read_b128 v[112:115], v8 offset:24576
  ds_read_b64_tr_b16 v[128:129], v14 offset:16384
  ds_read_b64_tr_b16 v[130:131], v14 offset:17408
  ds_read_b64_tr_b16 v[144:145], v15 offset:16384
  v_mfma_f32_32x32x16_bf16 v[32:47], v[96:99], v[64:67], v[32:47]
  ds_read_b64_tr_b16 v[146:147], v15 offset:17408
  ds_read_b128 v[116:119], v9 offset:24576
  ds_read_b64_tr_b16 v[132:133], v14 offset:20480
  v_mfma_f32_32x32x16_bf16 v[16:31], v[84:87], v[68:71], v[16:31]
  ds_read_b64_tr_b16 v[134:135], v14 offset:21504
  ds_read_b64_tr_b16 v[148:149], v15 offset:20480
  ds_read_b64_tr_b16 v[150:151], v15 offset:21504
  v_mfma_f32_32x32x16_bf16 v[32:47], v[100:103], v[68:71], v[32:47]
  ds_read_b128 v[120:123], v10 offset:24576
  ds_read_b64_tr_b16 v[136:137], v14 offset:24576
  ds_read_b64_tr_b16 v[138:139], v14 offset:25600
  ds_read_b64_tr_b16 v[152:153], v15 offset:24576
  v_mfma_f32_32x32x16_bf16 v[16:31], v[88:91], v[72:75], v[16:31]
  ds_read_b64_tr_b16 v[154:155], v15 offset:25600
  ds_read_b128 v[124:127], v11 offset:24576
  ds_read_b64_tr_b16 v[140:141], v14 offset:28672
  v_mfma_f32_32x32x16_bf16 v[32:47], v[104:107], v[72:75], v[32:47]
  ds_read_b64_tr_b16 v[142:143], v14 offset:29696
  ds_read_b64_tr_b16 v[156:157], v15 offset:28672
  ds_read_b64_tr_b16 v[158:159], v15 offset:29696
  v_mfma_f32_32x32x16_bf16 v[16:31], v[92:95], v[76:79], v[16:31]
  v_mfma_f32_32x32x16_bf16 v[32:47], v[108:111], v[76:79], v[32:47]
  s_waitcnt lgkmcnt(0)
  s_barrier
  v_mfma_f32_32x32x16_bf16 v[16:31], v[128:131], v[112:115], v[16:31]
  v_mfma_f32_32x32x16_bf16 v[32:47], v[144:147], v[112:115], v[32:47]
  v_mfma_f32_32x32x16_bf16 v[16:31], v[132:135], v[116:119], v[16:31]
  v_mfma_f32_32x32x16_bf16 v[32:47], v[148:151], v[116:119], v[32:47]
  v_mfma_f32_32x32x16_bf16 v[16:31], v[136:139], v[120:123], v[16:31]
  v_mfma_f32_32x32x16_bf16 v[32:47], v[152:155], v[120:123], v[32:47]
  v_mfma_f32_32x32x16_bf16 v[16:31], v[140:143], v[124:127], v[16:31]
  v_mfma_f32_32x32x16_bf16 v[32:47], v[156:159], v[124:127], v[32:47]
  s_lshl_b32 s24, s21, 1
  s_add_u32 s24, s24, s27
  s_lshl_b32 s24, s24, 5
  s_lshl_b32 s25, s20, 3
  s_add_u32 s24, s24, s25
  s_add_u32 s24, s24, s22
  s_lshl_b32 s24, s24, 13
  s_lshl_b32 s25, s28, 12
  s_add_u32 s24, s24, s25
  s_mov_b32 s25, 0
  s_add_u32 s48, s18, s25
  s_addc_u32 s49, s19, 0
  s_mov_b32 s50, 4194304
  s_mov_b32 s51, 0x20000
  v_mov_b32 v62, 0x3e0293ee
  v_mov_b32 v63, 0x3e0293ee
  v_pk_mul_f32 v[16:17], v[16:17], v[62:63]
  v_pk_mul_f32 v[18:19], v[18:19], v[62:63]
  v_pk_mul_f32 v[20:21], v[20:21], v[62:63]
  v_pk_mul_f32 v[22:23], v[22:23], v[62:63]
  v_pk_mul_f32 v[24:25], v[24:25], v[62:63]
  v_pk_mul_f32 v[26:27], v[26:27], v[62:63]
  v_pk_mul_f32 v[28:29], v[28:29], v[62:63]
  v_pk_mul_f32 v[30:31], v[30:31], v[62:63]
  v_pk_mul_f32 v[32:33], v[32:33], v[62:63]
  v_pk_mul_f32 v[34:35], v[34:35], v[62:63]
  v_pk_mul_f32 v[36:37], v[36:37], v[62:63]
  v_pk_mul_f32 v[38:39], v[38:39], v[62:63]
  v_pk_mul_f32 v[40:41], v[40:41], v[62:63]
  v_pk_mul_f32 v[42:43], v[42:43], v[62:63]
  v_pk_mul_f32 v[44:45], v[44:45], v[62:63]
  v_pk_mul_f32 v[46:47], v[46:47], v[62:63]
  v_cvt_pk_bf16_f32 v64, v16, v17
  v_cvt_pk_bf16_f32 v65, v18, v19
  v_cvt_pk_bf16_f32 v66, v20, v21
  v_cvt_pk_bf16_f32 v67, v22, v23
  v_cvt_pk_bf16_f32 v68, v24, v25
  v_cvt_pk_bf16_f32 v69, v26, v27
  v_cvt_pk_bf16_f32 v70, v28, v29
  v_cvt_pk_bf16_f32 v71, v30, v31
  v_cvt_pk_bf16_f32 v72, v32, v33
  v_cvt_pk_bf16_f32 v73, v34, v35
  v_cvt_pk_bf16_f32 v74, v36, v37
  v_cvt_pk_bf16_f32 v75, v38, v39
  v_cvt_pk_bf16_f32 v76, v40, v41
  v_cvt_pk_bf16_f32 v77, v42, v43
  v_cvt_pk_bf16_f32 v78, v44, v45
  v_cvt_pk_bf16_f32 v79, v46, v47
  s_xor_b32 s25, s23, s22
  s_and_b32 s83, s25, 1
  s_cmp_lg_u32 s83, 0
  s_cbranch_scc1 standalone__gqa_block_cached__near_ridge_kernel_qpart_9
  s_lshl_b32 s25, s28, 12
  s_add_u32 s25, s25, 0
  v_add_u32 v3, s25, v2
  ds_write_b128 v3, v[64:67]
  ds_write_b128 v3, v[68:71] offset:1024
  ds_write_b128 v3, v[72:75] offset:2048
  ds_write_b128 v3, v[76:79] offset:3072
  s_waitcnt lgkmcnt(0)
  s_branch standalone__gqa_block_cached__near_ridge_kernel_qjoin_10
standalone__gqa_block_cached__near_ridge_kernel_qpart_9:
  buffer_store_dwordx4 v[64:67], v2, s[48:51], s24 offen sc1
  buffer_store_dwordx4 v[68:71], v2, s[48:51], s24 offen offset:1024 sc1
  buffer_store_dwordx4 v[72:75], v2, s[48:51], s24 offen offset:2048 sc1
  buffer_store_dwordx4 v[76:79], v2, s[48:51], s24 offen offset:3072 sc1
  v_mov_b32 v60, s82
  v_mov_b32 v61, 0
  s_lshl_b32 s24, s29, 1
  s_add_u32 s24, s24, s28
  s_lshl_b32 s24, s24, 7
  s_waitcnt vmcnt(0)
  s_mov_b64 exec, 1
  s_cmp_eq_u32 s8, 0
  s_cbranch_scc1 standalone__gqa_block_cached__near_ridge_kernel_loc_11
  buffer_store_dword v60, v61, s[68:71], s24 offen
standalone__gqa_block_cached__near_ridge_kernel_locj_12:
  s_mov_b64 exec, -1
standalone__gqa_block_cached__near_ridge_kernel_qjoin_10:
  s_barrier
  s_cmp_eq_u32 s83, 0
  s_cbranch_scc1 standalone__gqa_block_cached__near_ridge_kernel_qnopoll_13
  s_cmp_lg_u32 s28, 0
  s_cbranch_scc1 standalone__gqa_block_cached__near_ridge_kernel_qnopoll_13
  s_xor_b32 s1, s29, 1
  s_lshl_b32 s1, s1, 8
  v_lshlrev_b32 v61, 7, v1
  s_mov_b64 exec, 3
  buffer_load_dword v62, v61, s[68:71], s1 offen sc1
  s_mov_b64 exec, -1
standalone__gqa_block_cached__near_ridge_kernel_qnopoll_13:
  v_and_b32 v3, 31, v1
  v_and_b32 v4, 19, v3
  v_bfe_u32 v5, v3, 2, 1
  v_lshl_or_b32 v4, v5, 3, v4
  v_bfe_u32 v5, v3, 3, 1
  v_lshl_or_b32 v4, v5, 2, v4
  v_and_b32 v5, 15, v4
  v_lshrrev_b32 v6, 5, v1
  v_xor_b32 v5, v5, v6
  s_lshl_b32 s79, s28, 13
  s_add_u32 s3, s79, 98304
  v_lshl_add_u32 v4, v4, 8, s3
  v_xor_b32 v6, 0, v5
  v_lshl_add_u32 v8, v6, 4, v4
  v_xor_b32 v6, 2, v5
  v_lshl_add_u32 v9, v6, 4, v4
  v_xor_b32 v6, 4, v5
  v_lshl_add_u32 v10, v6, 4, v4
  v_xor_b32 v6, 6, v5
  v_lshl_add_u32 v11, v6, 4, v4
  v_xor_b32 v6, 8, v5
  v_lshl_add_u32 v12, v6, 4, v4
  v_xor_b32 v6, 10, v5
  v_lshl_add_u32 v13, v6, 4, v4
  v_xor_b32 v6, 12, v5
  v_lshl_add_u32 v14, v6, 4, v4
  v_xor_b32 v6, 14, v5
  v_lshl_add_u32 v15, v6, 4, v4
  s_lshl_b32 s24, s28, 3
  s_xor_b32 s4, s24, 0
  s_xor_b32 s5, s24, 4
  s_xor_b32 s6, s24, 8
  s_xor_b32 s7, s24, 12
  s_add_u32 s3, s79, 0
  v_and_b32 v3, 15, v1
  v_lshrrev_b32 v4, 2, v3
  v_lshrrev_b32 v5, 5, v1
  v_lshl_add_u32 v5, v5, 3, v4
  v_lshlrev_b32 v5, 8, v5
  v_bfe_u32 v7, v3, 1, 1
  v_lshl_add_u32 v5, v7, 3, v5
  v_and_b32 v6, 1, v3
  v_bfe_u32 v7, v1, 4, 1
  v_lshl_add_u32 v6, v7, 1, v6
  v_lshlrev_b32 v4, 2, v4
  v_add_u32 v7, s4, v6
  v_xor_b32 v7, v7, v4
  v_lshl_add_u32 v16, v7, 4, v5
  v_add_u32 v16, s3, v16
  v_add_u32 v7, s5, v6
  v_xor_b32 v7, v7, v4
  v_lshl_add_u32 v17, v7, 4, v5
  v_add_u32 v17, s3, v17
  v_add_u32 v7, s6, v6
  v_xor_b32 v7, v7, v4
  v_lshl_add_u32 v18, v7, 4, v5
  v_add_u32 v18, s3, v18
  v_add_u32 v7, s7, v6
  v_xor_b32 v7, v7, v4
  v_lshl_add_u32 v19, v7, 4, v5
  v_add_u32 v19, s3, v19
  s_mov_b32 s31, 0x3e0293ee
  s_and_b32 s77, s22, 1
  s_lshl_b32 s24, s21, 1
  s_add_u32 s77, s77, s24
  s_and_b32 s24, s22, 6
  s_lshl_b32 s25, s20, 3
  s_add_u32 s24, s24, s25
  s_add_u32 s24, s24, s27
  s_lshl_b32 s78, s77, 5
  s_add_u32 s78, s78, s24
  s_lshl_b32 s78, s78, 13
  s_cmp_lg_u32 s83, 0
  s_cbranch_scc1 standalone__gqa_block_cached__near_ridge_kernel_qpart2_14
  v_add_u32 v59, 0, v2
  ds_read_b128 v[96:99], v59
  ds_read_b128 v[100:103], v59 offset:1024
  ds_read_b128 v[104:107], v59 offset:2048
  ds_read_b128 v[108:111], v59 offset:3072
  ds_read_b128 v[112:115], v59 offset:4096
  ds_read_b128 v[116:119], v59 offset:5120
  ds_read_b128 v[120:123], v59 offset:6144
  ds_read_b128 v[124:127], v59 offset:7168
  s_waitcnt lgkmcnt(0)
  s_branch standalone__gqa_block_cached__near_ridge_kernel_qjoin2_15
standalone__gqa_block_cached__near_ridge_kernel_qpart2_14:
  v_mov_b32 v59, 8192
  s_cmp_lg_u32 s28, 0
  s_cbranch_scc1 standalone__gqa_block_cached__near_ridge_kernel_qwaitlds_16
  s_mov_b64 exec, 3
  s_mov_b32 s30, 0
standalone__gqa_block_cached__near_ridge_kernel_poll_19:
  s_waitcnt vmcnt(0)
  v_cmp_ne_u32 vcc, s82, v62
  s_add_u32 s30, s30, 1
  s_cbranch_vccz standalone__gqa_block_cached__near_ridge_kernel_pdone_20
  s_sleep 1
  buffer_load_dword v62, v61, s[68:71], s1 offen sc1
  s_cmp_lt_u32 s30, 40000
  s_cbranch_scc1 standalone__gqa_block_cached__near_ridge_kernel_poll_19
  s_waitcnt vmcnt(0)
standalone__gqa_block_cached__near_ridge_kernel_pdone_20:
  s_mov_b64 exec, -1
  v_mov_b32 v60, s82
  ds_write_b32 v59, v60
  s_branch standalone__gqa_block_cached__near_ridge_kernel_qgo_17
standalone__gqa_block_cached__near_ridge_kernel_qwaitlds_16:
  s_mov_b32 s30, 0
standalone__gqa_block_cached__near_ridge_kernel_qspin_18:
  ds_read_b32 v60, v59
  s_waitcnt lgkmcnt(0)
  v_readfirstlane_b32 s24, v60
  s_add_u32 s30, s30, 1
  s_nop 2
  s_cmp_eq_u32 s24, s82
  s_cbranch_scc1 standalone__gqa_block_cached__near_ridge_kernel_qgo_17
  s_sleep 1
  s_cmp_lt_u32 s30, 320000
  s_cbranch_scc1 standalone__gqa_block_cached__near_ridge_kernel_qspin_18
standalone__gqa_block_cached__near_ridge_kernel_qgo_17:
  s_add_u32 s24, s78, 4096
  buffer_load_dwordx4 v[96:99], v2, s[48:51], s78 offen sc1
  buffer_load_dwordx4 v[100:103], v2, s[48:51], s78 offen offset:1024 sc1
  buffer_load_dwordx4 v[104:107], v2, s[48:51], s78 offen offset:2048 sc1
  buffer_load_dwordx4 v[108:111], v2, s[48:51], s78 offen offset:3072 sc1
  buffer_load_dwordx4 v[112:115], v2, s[48:51], s24 offen sc1
  buffer_load_dwordx4 v[116:119], v2, s[48:51], s24 offen offset:1024 sc1
  buffer_load_dwordx4 v[120:123], v2, s[48:51], s24 offen offset:2048 sc1
  buffer_load_dwordx4 v[124:127], v2, s[48:51], s24 offen offset:3072 sc1
  s_waitcnt vmcnt(0)
  s_waitcnt lgkmcnt(0)
standalone__gqa_block_cached__near_ridge_kernel_qjoin2_15:
  s_barrier
  ds_read_b128 v[32:35], v8
  ds_read_b128 v[36:39], v9
  ds_read_b128 v[40:43], v10
  ds_read_b128 v[44:47], v11
  ds_read_b128 v[48:51], v12
  ds_read_b128 v[52:55], v13
  ds_read_b128 v[56:59], v14
  ds_read_b128 v[60:63], v15
  s_waitcnt lgkmcnt(0)
  s_barrier
  v_mfma_f32_32x32x16_bf16 v[128:143], v[32:35], v[96:99], 0
  ds_read_b128 v[64:67], v8 offset:16384
  ds_read_b128 v[68:71], v9 offset:16384
  v_mfma_f32_32x32x16_bf16 v[128:143], v[36:39], v[100:103], v[128:143]
  ds_read_b128 v[72:75], v10 offset:16384
  v_mfma_f32_32x32x16_bf16 v[128:143], v[40:43], v[104:107], v[128:143]
  ds_read_b128 v[76:79], v11 offset:16384
  v_mfma_f32_32x32x16_bf16 v[128:143], v[44:47], v[108:111], v[128:143]
  ds_read_b128 v[80:83], v12 offset:16384
  ds_read_b128 v[84:87], v13 offset:16384
  v_mfma_f32_32x32x16_bf16 v[128:143], v[48:51], v[112:115], v[128:143]
  ds_read_b128 v[88:91], v14 offset:16384
  v_mfma_f32_32x32x16_bf16 v[128:143], v[52:55], v[116:119], v[128:143]
  ds_read_b128 v[92:95], v15 offset:16384
  v_mfma_f32_32x32x16_bf16 v[128:143], v[56:59], v[120:123], v[128:143]
  v_mfma_f32_32x32x16_bf16 v[128:143], v[60:63], v[124:127], v[128:143]
  s_waitcnt lgkmcnt(0)
  s_barrier
  v_mfma_f32_32x32x16_bf16 v[144:159], v[64:67], v[96:99], 0
  ds_read_b128 v[32:35], v8 offset:32768
  ds_read_b128 v[36:39], v9 offset:32768
  s_nop 6
  v_max_f32 v20, v128, v129
  v_mfma_f32_32x32x16_bf16 v[144:159], v[68:71], v[100:103], v[144:159]
  ds_read_b128 v[40:43], v10 offset:32768
  v_max_f32 v21, v130, v131
  v_mfma_f32_32x32x16_bf16 v[144:159], v[72:75], v[104:107], v[144:159]
  ds_read_b128 v[44:47], v11 offset:32768
  v_max3_f32 v20, v132, v133, v20
  v_mfma_f32_32x32x16_bf16 v[144:159], v[76:79], v[108:111], v[144:159]
  ds_read_b128 v[48:51], v12 offset:32768
  ds_read_b128 v[52:55], v13 offset:32768
  v_max3_f32 v21, v134, v135, v21
  v_mfma_f32_32x32x16_bf16 v[144:159], v[80:83], v[112:115], v[144:159]
  ds_read_b128 v[56:59], v14 offset:32768
  v_max3_f32 v20, v136, v137, v20
  v_mfma_f32_32x32x16_bf16 v[144:159], v[84:87], v[116:119], v[144:159]
  ds_read_b128 v[60:63], v15 offset:32768
  v_max3_f32 v21, v138, v139, v21
  v_mfma_f32_32x32x16_bf16 v[144:159], v[88:91], v[120:123], v[144:159]
  v_max3_f32 v20, v140, v141, v20
  v_mfma_f32_32x32x16_bf16 v[144:159], v[92:95], v[124:127], v[144:159]
  v_max3_f32 v21, v142, v143, v21
  s_waitcnt lgkmcnt(0)
  s_barrier
  v_mfma_f32_32x32x16_bf16 v[160:175], v[32:35], v[96:99], 0
  ds_read_b128 v[64:67], v8 offset:49152
  ds_read_b128 v[68:71], v9 offset:49152
  s_nop 5
  v_max3_f32 v20, v144, v145, v20
  v_mfma_f32_32x32x16_bf16 v[160:175], v[36:39], v[100:103], v[160:175]
  ds_read_b128 v[72:75], v10 offset:49152
  v_max3_f32 v21, v146, v147, v21
  v_mfma_f32_32x32x16_bf16 v[160:175], v[40:43], v[104:107], v[160:175]
  ds_read_b128 v[76:79], v11 offset:49152
  v_max3_f32 v20, v148, v149, v20
  v_mfma_f32_32x32x16_bf16 v[160:175], v[44:47], v[108:111], v[160:175]
  ds_read_b128 v[80:83], v12 offset:49152
  ds_read_b128 v[84:87], v13 offset:49152
  v_max3_f32 v21, v150, v151, v21
  v_mfma_f32_32x32x16_bf16 v[160:175], v[48:51], v[112:115], v[160:175]
  ds_read_b128 v[88:91], v14 offset:49152
  v_max3_f32 v20, v152, v153, v20
  v_mfma_f32_32x32x16_bf16 v[160:175], v[52:55], v[116:119], v[160:175]
  ds_read_b128 v[92:95], v15 offset:49152
  v_max3_f32 v21, v154, v155, v21
  v_mfma_f32_32x32x16_bf16 v[160:175], v[56:59], v[120:123], v[160:175]
  v_max3_f32 v20, v156, v157, v20
  v_mfma_f32_32x32x16_bf16 v[160:175], v[60:63], v[124:127], v[160:175]
  v_max3_f32 v21, v158, v159, v21
  s_waitcnt lgkmcnt(0)
  s_barrier
  v_subrev_u32 v8, 65536, v8
  v_subrev_u32 v9, 65536, v9
  v_subrev_u32 v10, 65536, v10
  v_subrev_u32 v11, 65536, v11
  v_subrev_u32 v12, 65536, v12
  v_subrev_u32 v13, 65536, v13
  v_subrev_u32 v14, 65536, v14
  v_subrev_u32 v15, 65536, v15
  v_mfma_f32_32x32x16_bf16 v[176:191], v[64:67], v[96:99], 0
  ds_read_b128 v[32:35], v8
  ds_read_b128 v[36:39], v9
  v_max3_f32 v20, v160, v161, v20
  v_mfma_f32_32x32x16_bf16 v[176:191], v[68:71], v[100:103], v[176:191]
  ds_read_b128 v[40:43], v10
  v_max3_f32 v21, v162, v163, v21
  v_mfma_f32_32x32x16_bf16 v[176:191], v[72:75], v[104:107], v[176:191]
  ds_read_b128 v[44:47], v11
  v_max3_f32 v20, v164, v165, v20
  v_mfma_f32_32x32x16_bf16 v[176:191], v[76:79], v[108:111], v[176:191]
  ds_read_b128 v[48:51], v12
  ds_read_b128 v[52:55], v13
  v_max3_f32 v21, v166, v167, v21
  v_mfma_f32_32x32x16_bf16 v[176:191], v[80:83], v[112:115], v[176:191]
  ds_read_b128 v[56:59], v14
  v_max3_f32 v20, v168, v169, v20
  v_mfma_f32_32x32x16_bf16 v[176:191], v[84:87], v[116:119], v[176:191]
  ds_read_b128 v[60:63], v15
  v_max3_f32 v21, v170, v171, v21
  v_mfma_f32_32x32x16_bf16 v[176:191], v[88:91], v[120:123], v[176:191]
  v_max3_f32 v20, v172, v173, v20
  v_mfma_f32_32x32x16_bf16 v[176:191], v[92:95], v[124:127], v[176:191]
  v_max3_f32 v21, v174, v175, v21
  s_waitcnt lgkmcnt(0)
  s_barrier
  v_mfma_f32_32x32x16_bf16 v[192:207], v[32:35], v[96:99], 0
  ds_read_b128 v[64:67], v8 offset:16384
  ds_read_b128 v[68:71], v9 offset:16384
  s_nop 5
  v_max3_f32 v20, v176, v177, v20
  v_mfma_f32_32x32x16_bf16 v[192:207], v[36:39], v[100:103], v[192:207]
  ds_read_b128 v[72:75], v10 offset:16384
  v_max3_f32 v21, v178, v179, v21
  v_mfma_f32_32x32x16_bf16 v[192:207], v[40:43], v[104:107], v[192:207]
  ds_read_b128 v[76:79], v11 offset:16384
  v_max3_f32 v20, v180, v181, v20
  v_mfma_f32_32x32x16_bf16 v[192:207], v[44:47], v[108:111], v[192:207]
  ds_read_b128 v[80:83], v12 offset:16384
  ds_read_b128 v[84:87], v13 offset:16384
  v_max3_f32 v21, v182, v183, v21
  v_mfma_f32_32x32x16_bf16 v[192:207], v[48:51], v[112:115], v[192:207]
  ds_read_b128 v[88:91], v14 offset:16384
  v_max3_f32 v20, v184, v185, v20
  v_mfma_f32_32x32x16_bf16 v[192:207], v[52:55], v[116:119], v[192:207]
  ds_read_b128 v[92:95], v15 offset:16384
  v_max3_f32 v21, v186, v187, v21
  v_mfma_f32_32x32x16_bf16 v[192:207], v[56:59], v[120:123], v[192:207]
  v_max3_f32 v20, v188, v189, v20
  v_mfma_f32_32x32x16_bf16 v[192:207], v[60:63], v[124:127], v[192:207]
  v_max3_f32 v21, v190, v191, v21
  s_waitcnt lgkmcnt(0)
  s_barrier
  v_mfma_f32_32x32x16_bf16 v[208:223], v[64:67], v[96:99], 0
  ds_read_b128 v[32:35], v8 offset:32768
  ds_read_b128 v[36:39], v9 offset:32768
  s_nop 5
  v_max3_f32 v20, v192, v193, v20
  v_mfma_f32_32x32x16_bf16 v[208:223], v[68:71], v[100:103], v[208:223]
  ds_read_b128 v[40:43], v10 offset:32768
  v_max3_f32 v21, v194, v195, v21
  v_mfma_f32_32x32x16_bf16 v[208:223], v[72:75], v[104:107], v[208:223]
  ds_read_b128 v[44:47], v11 offset:32768
  v_max3_f32 v20, v196, v197, v20
  v_mfma_f32_32x32x16_bf16 v[208:223], v[76:79], v[108:111], v[208:223]
  ds_read_b128 v[48:51], v12 offset:32768
  ds_read_b128 v[52:55], v13 offset:32768
  v_max3_f32 v21, v198, v199, v21
  v_mfma_f32_32x32x16_bf16 v[208:223], v[80:83], v[112:115], v[208:223]
  ds_read_b128 v[56:59], v14 offset:32768
  v_max3_f32 v20, v200, v201, v20
  v_mfma_f32_32x32x16_bf16 v[208:223], v[84:87], v[116:119], v[208:223]
  ds_read_b128 v[60:63], v15 offset:32768
  v_max3_f32 v21, v202, v203, v21
  v_mfma_f32_32x32x16_bf16 v[208:223], v[88:91], v[120:123], v[208:223]
  v_max3_f32 v20, v204, v205, v20
  v_mfma_f32_32x32x16_bf16 v[208:223], v[92:95], v[124:127], v[208:223]
  v_max3_f32 v21, v206, v207, v21
  s_waitcnt lgkmcnt(0)
  s_barrier
  v_mfma_f32_32x32x16_bf16 v[224:239], v[32:35], v[96:99], 0
  ds_read_b128 v[64:67], v8 offset:49152
  ds_read_b128 v[68:71], v9 offset:49152
  s_nop 5
  v_max3_f32 v20, v208, v209, v20
  v_mfma_f32_32x32x16_bf16 v[224:239], v[36:39], v[100:103], v[224:239]
  ds_read_b128 v[72:75], v10 offset:49152
  v_max3_f32 v21, v210, v211, v21
  v_mfma_f32_32x32x16_bf16 v[224:239], v[40:43], v[104:107], v[224:239]
  ds_read_b128 v[76:79], v11 offset:49152
  v_max3_f32 v20, v212, v213, v20
  v_mfma_f32_32x32x16_bf16 v[224:239], v[44:47], v[108:111], v[224:239]
  ds_read_b128 v[80:83], v12 offset:49152
  ds_read_b128 v[84:87], v13 offset:49152
  v_max3_f32 v21, v214, v215, v21
  v_mfma_f32_32x32x16_bf16 v[224:239], v[48:51], v[112:115], v[224:239]
  ds_read_b128 v[88:91], v14 offset:49152
  v_max3_f32 v20, v216, v217, v20
  v_mfma_f32_32x32x16_bf16 v[224:239], v[52:55], v[116:119], v[224:239]
  ds_read_b128 v[92:95], v15 offset:49152
  v_max3_f32 v21, v218, v219, v21
  v_mfma_f32_32x32x16_bf16 v[224:239], v[56:59], v[120:123], v[224:239]
  v_max3_f32 v20, v220, v221, v20
  v_mfma_f32_32x32x16_bf16 v[224:239], v[60:63], v[124:127], v[224:239]
  v_max3_f32 v21, v222, v223, v21
  s_waitcnt lgkmcnt(0)
  s_barrier
  v_mfma_f32_32x32x16_bf16 v[240:255], v[64:67], v[96:99], 0
  ds_read_b64_tr_b16 v[32:33], v16
  ds_read_b64_tr_b16 v[34:35], v16 offset:1024
  s_nop 5
  v_max3_f32 v20, v224, v225, v20
  v_mfma_f32_32x32x16_bf16 v[240:255], v[68:71], v[100:103], v[240:255]
  ds_read_b64_tr_b16 v[36:37], v17
  ds_read_b64_tr_b16 v[38:39], v17 offset:1024
  v_max3_f32 v21, v226, v227, v21
  v_mfma_f32_32x32x16_bf16 v[240:255], v[72:75], v[104:107], v[240:255]
  ds_read_b64_tr_b16 v[40:41], v18
  ds_read_b64_tr_b16 v[42:43], v18 offset:1024
  v_max3_f32 v20, v228, v229, v20
  v_mfma_f32_32x32x16_bf16 v[240:255], v[76:79], v[108:111], v[240:255]
  ds_read_b64_tr_b16 v[44:45], v19
  ds_read_b64_tr_b16 v[46:47], v19 offset:1024
  v_max3_f32 v21, v230, v231, v21
  v_mfma_f32_32x32x16_bf16 v[240:255], v[80:83], v[112:115], v[240:255]
  ds_read_b64_tr_b16 v[48:49], v16 offset:4096
  ds_read_b64_tr_b16 v[50:51], v16 offset:5120
  v_max3_f32 v20, v232, v233, v20
  v_mfma_f32_32x32x16_bf16 v[240:255], v[84:87], v[116:119], v[240:255]
  ds_read_b64_tr_b16 v[52:53], v17 offset:4096
  ds_read_b64_tr_b16 v[54:55], v17 offset:5120
  v_max3_f32 v21, v234, v235, v21
  v_mfma_f32_32x32x16_bf16 v[240:255], v[88:91], v[120:123], v[240:255]
  ds_read_b64_tr_b16 v[56:57], v18 offset:4096
  ds_read_b64_tr_b16 v[58:59], v18 offset:5120
  v_max3_f32 v20, v236, v237, v20
  v_mfma_f32_32x32x16_bf16 v[240:255], v[92:95], v[124:127], v[240:255]
  ds_read_b64_tr_b16 v[60:61], v19 offset:4096
  ds_read_b64_tr_b16 v[62:63], v19 offset:5120
  v_max3_f32 v21, v238, v239, v21
  v_and_b32 v22, 15, v1
  v_bfe_u32 v23, v1, 4, 1
  v_cmp_eq_u32 vcc, v22, v23
  v_mov_b32 v22, 0x3f803f80
  s_nop 0
  v_cndmask_b32 v8, 0, v22
  v_mov_b32 v9, v8
  v_mov_b32 v10, v8
  v_mov_b32 v11, v8
  v_cmp_gt_u32 vcc, 32, v1
  s_nop 1
  v_cndmask_b32 v12, 0, v22
  v_lshrrev_b32 v13, 16, v12
  v_mov_b32 v14, 0
  v_mov_b32 v15, 0
  v_max3_f32 v20, v240, v241, v20
  v_max3_f32 v21, v242, v243, v21
  v_max3_f32 v20, v244, v245, v20
  v_max3_f32 v21, v246, v247, v21
  v_max3_f32 v20, v248, v249, v20
  v_max3_f32 v21, v250, v251, v21
  v_max3_f32 v20, v252, v253, v20
  v_max3_f32 v21, v254, v255, v21
  v_max_f32 v3, v20, v21
  v_mov_b32 v22, v3
  s_nop 1
  v_permlane32_swap_b32 v22, v3
  v_max_f32 v3, v3, v22
  v_sub_f32 v22, 0, v3
  v_cvt_pk_bf16_f32 v23, v22, v22
  v_lshlrev_b32 v23, 16, v23
  v_sub_f32 v21, v22, v23
  v_cvt_pk_bf16_f32 v23, v21, v21
  v_lshlrev_b32 v23, 16, v23
  v_sub_f32 v23, v21, v23
  v_cvt_pk_bf16_f32 v20, v22, v21
  v_cvt_pk_bf16_f32 v21, v23, 0
  v_cndmask_b32 v20, 0, v20
  v_cndmask_b32 v21, 0, v21
  v_mov_b32 v22, 0
  v_mov_b32 v23, 0
  s_nop 1
  v_mfma_f32_32x32x16_bf16 v[128:143], v[12:15], v[20:23], v[128:143]
  v_mfma_f32_32x32x16_bf16 v[144:159], v[12:15], v[20:23], v[144:159]
  s_nop 10
  v_exp_f32 v128, v128
  v_exp_f32 v129, v129
  v_exp_f32 v130, v130
  v_exp_f32 v131, v131
  v_exp_f32 v132, v132
  v_exp_f32 v133, v133
  v_exp_f32 v134, v134
  v_exp_f32 v135, v135
  v_cvt_pk_bf16_f32 v128, v128, v129
  v_cvt_pk_bf16_f32 v129, v130, v131
  v_cvt_pk_bf16_f32 v130, v132, v133
  v_cvt_pk_bf16_f32 v131, v134, v135
  v_exp_f32 v136, v136
  v_exp_f32 v137, v137
  v_exp_f32 v138, v138
  v_exp_f32 v139, v139
  v_exp_f32 v140, v140
  v_exp_f32 v141, v141
  v_exp_f32 v142, v142
  v_exp_f32 v143, v143
  v_cvt_pk_bf16_f32 v132, v136, v137
  v_cvt_pk_bf16_f32 v133, v138, v139
  v_cvt_pk_bf16_f32 v134, v140, v141
  v_cvt_pk_bf16_f32 v135, v142, v143
  s_waitcnt lgkmcnt(8)
  s_barrier
  v_mfma_f32_16x16x32_bf16 v[24:27], v[8:11], v[128:131], 0
  ds_read_b64_tr_b16 v[136:137], v16 offset:16384
  ds_read_b64_tr_b16 v[138:139], v16 offset:17408
  v_exp_f32 v144, v144
  v_exp_f32 v145, v145
  v_mfma_f32_32x32x16_bf16 v[64:79], v[32:35], v[128:131], 0
  ds_read_b64_tr_b16 v[140:141], v17 offset:16384
  ds_read_b64_tr_b16 v[142:143], v17 offset:17408
  v_exp_f32 v146, v146
  v_exp_f32 v147, v147
  v_exp_f32 v148, v148
  v_mfma_f32_32x32x16_bf16 v[80:95], v[36:39], v[128:131], 0
  ds_read_b64_tr_b16 v[4:5], v18 offset:16384
  v_exp_f32 v149, v149
  v_exp_f32 v150, v150
  v_mfma_f32_32x32x16_bf16 v[96:111], v[40:43], v[128:131], 0
  ds_read_b64_tr_b16 v[6:7], v18 offset:17408
  ds_read_b64_tr_b16 v[28:29], v19 offset:16384
  v_exp_f32 v151, v151
  v_cvt_pk_bf16_f32 v144, v144, v145
  v_cvt_pk_bf16_f32 v145, v146, v147
  v_mfma_f32_32x32x16_bf16 v[112:127], v[44:47], v[128:131], 0
  ds_read_b64_tr_b16 v[30:31], v19 offset:17408
  v_cvt_pk_bf16_f32 v146, v148, v149
  v_cvt_pk_bf16_f32 v147, v150, v151
  s_waitcnt lgkmcnt(8)
  v_mfma_f32_32x32x16_bf16 v[160:175], v[12:15], v[20:23], v[160:175]
  ds_read_b64_tr_b16 v[32:33], v16 offset:20480
  ds_read_b64_tr_b16 v[34:35], v16 offset:21504
  v_exp_f32 v152, v152
  v_exp_f32 v153, v153
  v_mfma_f32_16x16x32_bf16 v[24:27], v[8:11], v[132:135], v[24:27]
  ds_read_b64_tr_b16 v[36:37], v17 offset:20480
  v_exp_f32 v154, v154
  v_exp_f32 v155, v155
  v_mfma_f32_32x32x16_bf16 v[64:79], v[48:51], v[132:135], v[64:79]
  ds_read_b64_tr_b16 v[38:39], v17 offset:21504
  v_exp_f32 v156, v156
  v_exp_f32 v157, v157
  v_mfma_f32_32x32x16_bf16 v[80:95], v[52:55], v[132:135], v[80:95]
  ds_read_b64_tr_b16 v[40:41], v18 offset:20480
  ds_read_b64_tr_b16 v[42:43], v18 offset:21504
  v_exp_f32 v158, v158
  v_exp_f32 v159, v159
  v_mfma_f32_32x32x16_bf16 v[96:111], v[56:59], v[132:135], v[96:111]
  ds_read_b64_tr_b16 v[44:45], v19 offset:20480
  v_cvt_pk_bf16_f32 v148, v152, v153
  v_cvt_pk_bf16_f32 v149, v154, v155
  v_mfma_f32_32x32x16_bf16 v[112:127], v[60:63], v[132:135], v[112:127]
  ds_read_b64_tr_b16 v[46:47], v19 offset:21504
  v_cvt_pk_bf16_f32 v150, v156, v157
  v_cvt_pk_bf16_f32 v151, v158, v159
  s_waitcnt lgkmcnt(8)
  s_barrier
  v_add_u32 v16, 98304, v16
  v_add_u32 v17, 98304, v17
  v_add_u32 v18, 98304, v18
  v_add_u32 v19, 98304, v19
  v_mfma_f32_16x16x32_bf16 v[24:27], v[8:11], v[144:147], v[24:27]
  ds_read_b64_tr_b16 v[48:49], v16
  ds_read_b64_tr_b16 v[50:51], v16 offset:1024
  v_exp_f32 v160, v160
  v_exp_f32 v161, v161
  v_mfma_f32_32x32x16_bf16 v[64:79], v[136:139], v[144:147], v[64:79]
  ds_read_b64_tr_b16 v[52:53], v17
  ds_read_b64_tr_b16 v[54:55], v17 offset:1024
  v_exp_f32 v162, v162
  v_exp_f32 v163, v163
  v_exp_f32 v164, v164
  v_mfma_f32_32x32x16_bf16 v[80:95], v[140:143], v[144:147], v[80:95]
  ds_read_b64_tr_b16 v[56:57], v18
  v_exp_f32 v165, v165
  v_exp_f32 v166, v166
  v_mfma_f32_32x32x16_bf16 v[96:111], v[4:7], v[144:147], v[96:111]
  ds_read_b64_tr_b16 v[58:59], v18 offset:1024
  ds_read_b64_tr_b16 v[60:61], v19
  v_exp_f32 v167, v167
  v_cvt_pk_bf16_f32 v160, v160, v161
  v_cvt_pk_bf16_f32 v161, v162, v163
  v_mfma_f32_32x32x16_bf16 v[112:127], v[28:31], v[144:147], v[112:127]
  ds_read_b64_tr_b16 v[62:63], v19 offset:1024
  v_cvt_pk_bf16_f32 v162, v164, v165
  v_cvt_pk_bf16_f32 v163, v166, v167
  s_waitcnt lgkmcnt(8)
  v_mfma_f32_32x32x16_bf16 v[176:191], v[12:15], v[20:23], v[176:191]
  ds_read_b64_tr_b16 v[136:137], v16 offset:4096
  ds_read_b64_tr_b16 v[138:139], v16 offset:5120
  v_exp_f32 v168, v168
  v_exp_f32 v169, v169
  v_mfma_f32_16x16x32_bf16 v[24:27], v[8:11], v[148:151], v[24:27]
  ds_read_b64_tr_b16 v[140:141], v17 offset:4096
  v_exp_f32 v170, v170
  v_exp_f32 v171, v171
  v_mfma_f32_32x32x16_bf16 v[64:79], v[32:35], v[148:151], v[64:79]
  ds_read_b64_tr_b16 v[142:143], v17 offset:5120
  v_exp_f32 v172, v172
  v_exp_f32 v173, v173
  v_mfma_f32_32x32x16_bf16 v[80:95], v[36:39], v[148:151], v[80:95]
  ds_read_b64_tr_b16 v[4:5], v18 offset:4096
  ds_read_b64_tr_b16 v[6:7], v18 offset:5120
  v_exp_f32 v174, v174
  v_exp_f32 v175, v175
  v_mfma_f32_32x32x16_bf16 v[96:111], v[40:43], v[148:151], v[96:111]
  ds_read_b64_tr_b16 v[28:29], v19 offset:4096
  v_cvt_pk_bf16_f32 v164, v168, v169
  v_cvt_pk_bf16_f32 v165, v170, v171
  v_mfma_f32_32x32x16_bf16 v[112:127], v[44:47], v[148:151], v[112:127]
  ds_read_b64_tr_b16 v[30:31], v19 offset:5120
  v_cvt_pk_bf16_f32 v166, v172, v173
  v_cvt_pk_bf16_f32 v167, v174, v175
  s_waitcnt lgkmcnt(8)
  s_barrier
  v_mfma_f32_16x16x32_bf16 v[24:27], v[8:11], v[160:163], v[24:27]
  ds_read_b64_tr_b16 v[32:33], v16 offset:16384
  ds_read_b64_tr_b16 v[34:35], v16 offset:17408
  v_exp_f32 v176, v176
  v_exp_f32 v177, v177
  v_mfma_f32_32x32x16_bf16 v[64:79], v[48:51], v[160:163], v[64:79]
  ds_read_b64_tr_b16 v[36:37], v17 offset:16384
  ds_read_b64_tr_b16 v[38:39], v17 offset:17408
  v_exp_f32 v178, v178
  v_exp_f32 v179, v179
  v_exp_f32 v180, v180
  v_mfma_f32_32x32x16_bf16 v[80:95], v[52:55], v[160:163], v[80:95]
  ds_read_b64_tr_b16 v[40:41], v18 offset:16384
  v_exp_f32 v181, v181
  v_exp_f32 v182, v182
  v_mfma_f32_32x32x16_bf16 v[96:111], v[56:59], v[160:163], v[96:111]
  ds_read_b64_tr_b16 v[42:43], v18 offset:17408
  ds_read_b64_tr_b16 v[44:45], v19 offset:16384
  v_exp_f32 v183, v183
  v_cvt_pk_bf16_f32 v176, v176, v177
  v_cvt_pk_bf16_f32 v177, v178, v179
  v_mfma_f32_32x32x16_bf16 v[112:127], v[60:63], v[160:163], v[112:127]
  ds_read_b64_tr_b16 v[46:47], v19 offset:17408
  v_cvt_pk_bf16_f32 v178, v180, v181
  v_cvt_pk_bf16_f32 v179, v182, v183
  s_waitcnt lgkmcnt(8)
  v_mfma_f32_32x32x16_bf16 v[192:207], v[12:15], v[20:23], v[192:207]
  ds_read_b64_tr_b16 v[48:49], v16 offset:20480
  ds_read_b64_tr_b16 v[50:51], v16 offset:21504
  v_exp_f32 v184, v184
  v_exp_f32 v185, v185
  v_mfma_f32_16x16x32_bf16 v[24:27], v[8:11], v[164:167], v[24:27]
  ds_read_b64_tr_b16 v[52:53], v17 offset:20480
  v_exp_f32 v186, v186
  v_exp_f32 v187, v187
  v_mfma_f32_32x32x16_bf16 v[64:79], v[136:139], v[164:167], v[64:79]
  ds_read_b64_tr_b16 v[54:55], v17 offset:21504
  v_exp_f32 v188, v188
  v_exp_f32 v189, v189
  v_mfma_f32_32x32x16_bf16 v[80:95], v[140:143], v[164:167], v[80:95]
  ds_read_b64_tr_b16 v[56:57], v18 offset:20480
  ds_read_b64_tr_b16 v[58:59], v18 offset:21504
  v_exp_f32 v190, v190
  v_exp_f32 v191, v191
  v_mfma_f32_32x32x16_bf16 v[96:111], v[4:7], v[164:167], v[96:111]
  ds_read_b64_tr_b16 v[60:61], v19 offset:20480
  v_cvt_pk_bf16_f32 v180, v184, v185
  v_cvt_pk_bf16_f32 v181, v186, v187
  v_mfma_f32_32x32x16_bf16 v[112:127], v[28:31], v[164:167], v[112:127]
  ds_read_b64_tr_b16 v[62:63], v19 offset:21504
  v_cvt_pk_bf16_f32 v182, v188, v189
  v_cvt_pk_bf16_f32 v183, v190, v191
  s_waitcnt lgkmcnt(8)
  s_barrier
  v_mfma_f32_16x16x32_bf16 v[24:27], v[8:11], v[176:179], v[24:27]
  ds_read_b64_tr_b16 v[136:137], v16 offset:32768
  ds_read_b64_tr_b16 v[138:139], v16 offset:33792
  v_exp_f32 v192, v192
  v_exp_f32 v193, v193
  v_mfma_f32_32x32x16_bf16 v[64:79], v[32:35], v[176:179], v[64:79]
  ds_read_b64_tr_b16 v[140:141], v17 offset:32768
  ds_read_b64_tr_b16 v[142:143], v17 offset:33792
  v_exp_f32 v194, v194
  v_exp_f32 v195, v195
  v_exp_f32 v196, v196
  v_mfma_f32_32x32x16_bf16 v[80:95], v[36:39], v[176:179], v[80:95]
  ds_read_b64_tr_b16 v[4:5], v18 offset:32768
  v_exp_f32 v197, v197
  v_exp_f32 v198, v198
  v_mfma_f32_32x32x16_bf16 v[96:111], v[40:43], v[176:179], v[96:111]
  ds_read_b64_tr_b16 v[6:7], v18 offset:33792
  ds_read_b64_tr_b16 v[28:29], v19 offset:32768
  v_exp_f32 v199, v199
  v_cvt_pk_bf16_f32 v192, v192, v193
  v_cvt_pk_bf16_f32 v193, v194, v195
  v_mfma_f32_32x32x16_bf16 v[112:127], v[44:47], v[176:179], v[112:127]
  ds_read_b64_tr_b16 v[30:31], v19 offset:33792
  v_cvt_pk_bf16_f32 v194, v196, v197
  v_cvt_pk_bf16_f32 v195, v198, v199
  s_waitcnt lgkmcnt(8)
  v_mfma_f32_32x32x16_bf16 v[208:223], v[12:15], v[20:23], v[208:223]
  ds_read_b64_tr_b16 v[32:33], v16 offset:36864
  ds_read_b64_tr_b16 v[34:35], v16 offset:37888
  v_exp_f32 v200, v200
  v_exp_f32 v201, v201
  v_mfma_f32_16x16x32_bf16 v[24:27], v[8:11], v[180:183], v[24:27]
  ds_read_b64_tr_b16 v[36:37], v17 offset:36864
  v_exp_f32 v202, v202
  v_exp_f32 v203, v203
  v_mfma_f32_32x32x16_bf16 v[64:79], v[48:51], v[180:183], v[64:79]
  ds_read_b64_tr_b16 v[38:39], v17 offset:37888
  v_exp_f32 v204, v204
  v_exp_f32 v205, v205
  v_mfma_f32_32x32x16_bf16 v[80:95], v[52:55], v[180:183], v[80:95]
  ds_read_b64_tr_b16 v[40:41], v18 offset:36864
  ds_read_b64_tr_b16 v[42:43], v18 offset:37888
  v_exp_f32 v206, v206
  v_exp_f32 v207, v207
  v_mfma_f32_32x32x16_bf16 v[96:111], v[56:59], v[180:183], v[96:111]
  ds_read_b64_tr_b16 v[44:45], v19 offset:36864
  v_cvt_pk_bf16_f32 v196, v200, v201
  v_cvt_pk_bf16_f32 v197, v202, v203
  v_mfma_f32_32x32x16_bf16 v[112:127], v[60:63], v[180:183], v[112:127]
  ds_read_b64_tr_b16 v[46:47], v19 offset:37888
  v_cvt_pk_bf16_f32 v198, v204, v205
  v_cvt_pk_bf16_f32 v199, v206, v207
  s_waitcnt lgkmcnt(8)
  s_barrier
  v_mfma_f32_16x16x32_bf16 v[24:27], v[8:11], v[192:195], v[24:27]
  ds_read_b64_tr_b16 v[48:49], v16 offset:49152
  ds_read_b64_tr_b16 v[50:51], v16 offset:50176
  v_exp_f32 v208, v208
  v_exp_f32 v209, v209
  v_mfma_f32_32x32x16_bf16 v[64:79], v[136:139], v[192:195], v[64:79]
  ds_read_b64_tr_b16 v[52:53], v17 offset:49152
  ds_read_b64_tr_b16 v[54:55], v17 offset:50176
  v_exp_f32 v210, v210
  v_exp_f32 v211, v211
  v_exp_f32 v212, v212
  v_mfma_f32_32x32x16_bf16 v[80:95], v[140:143], v[192:195], v[80:95]
  ds_read_b64_tr_b16 v[56:57], v18 offset:49152
  v_exp_f32 v213, v213
  v_exp_f32 v214, v214
  v_mfma_f32_32x32x16_bf16 v[96:111], v[4:7], v[192:195], v[96:111]
  ds_read_b64_tr_b16 v[58:59], v18 offset:50176
  ds_read_b64_tr_b16 v[60:61], v19 offset:49152
  v_exp_f32 v215, v215
  v_cvt_pk_bf16_f32 v208, v208, v209
  v_cvt_pk_bf16_f32 v209, v210, v211
  v_mfma_f32_32x32x16_bf16 v[112:127], v[28:31], v[192:195], v[112:127]
  ds_read_b64_tr_b16 v[62:63], v19 offset:50176
  v_cvt_pk_bf16_f32 v210, v212, v213
  v_cvt_pk_bf16_f32 v211, v214, v215
  s_waitcnt lgkmcnt(8)
  v_mfma_f32_32x32x16_bf16 v[224:239], v[12:15], v[20:23], v[224:239]
  ds_read_b64_tr_b16 v[136:137], v16 offset:53248
  ds_read_b64_tr_b16 v[138:139], v16 offset:54272
  v_exp_f32 v216, v216
  v_exp_f32 v217, v217
  v_mfma_f32_16x16x32_bf16 v[24:27], v[8:11], v[196:199], v[24:27]
  ds_read_b64_tr_b16 v[140:141], v17 offset:53248
  v_exp_f32 v218, v218
  v_exp_f32 v219, v219
  v_mfma_f32_32x32x16_bf16 v[64:79], v[32:35], v[196:199], v[64:79]
  ds_read_b64_tr_b16 v[142:143], v17 offset:54272
  v_exp_f32 v220, v220
  v_exp_f32 v221, v221
  v_mfma_f32_32x32x16_bf16 v[80:95], v[36:39], v[196:199], v[80:95]
  ds_read_b64_tr_b16 v[4:5], v18 offset:53248
  ds_read_b64_tr_b16 v[6:7], v18 offset:54272
  v_exp_f32 v222, v222
  v_exp_f32 v223, v223
  v_mfma_f32_32x32x16_bf16 v[96:111], v[40:43], v[196:199], v[96:111]
  ds_read_b64_tr_b16 v[28:29], v19 offset:53248
  v_cvt_pk_bf16_f32 v212, v216, v217
  v_cvt_pk_bf16_f32 v213, v218, v219
  v_mfma_f32_32x32x16_bf16 v[112:127], v[44:47], v[196:199], v[112:127]
  ds_read_b64_tr_b16 v[30:31], v19 offset:54272
  v_cvt_pk_bf16_f32 v214, v220, v221
  v_cvt_pk_bf16_f32 v215, v222, v223
  s_waitcnt lgkmcnt(8)
  s_barrier
  v_subrev_u32 v16, 65536, v16
  v_subrev_u32 v17, 65536, v17
  v_subrev_u32 v18, 65536, v18
  v_subrev_u32 v19, 65536, v19
  v_mfma_f32_16x16x32_bf16 v[24:27], v[8:11], v[208:211], v[24:27]
  ds_read_b64_tr_b16 v[32:33], v16
  ds_read_b64_tr_b16 v[34:35], v16 offset:1024
  v_exp_f32 v224, v224
  v_exp_f32 v225, v225
  v_mfma_f32_32x32x16_bf16 v[64:79], v[48:51], v[208:211], v[64:79]
  ds_read_b64_tr_b16 v[36:37], v17
  ds_read_b64_tr_b16 v[38:39], v17 offset:1024
  v_exp_f32 v226, v226
  v_exp_f32 v227, v227
  v_exp_f32 v228, v228
  v_mfma_f32_32x32x16_bf16 v[80:95], v[52:55], v[208:211], v[80:95]
  ds_read_b64_tr_b16 v[40:41], v18
  v_exp_f32 v229, v229
  v_exp_f32 v230, v230
  v_mfma_f32_32x32x16_bf16 v[96:111], v[56:59], v[208:211], v[96:111]
  ds_read_b64_tr_b16 v[42:43], v18 offset:1024
  ds_read_b64_tr_b16 v[44:45], v19
  v_exp_f32 v231, v231
  v_cvt_pk_bf16_f32 v224, v224, v225
  v_cvt_pk_bf16_f32 v225, v226, v227
  v_mfma_f32_32x32x16_bf16 v[112:127], v[60:63], v[208:211], v[112:127]
  ds_read_b64_tr_b16 v[46:47], v19 offset:1024
  v_cvt_pk_bf16_f32 v226, v228, v229
  v_cvt_pk_bf16_f32 v227, v230, v231
  s_waitcnt lgkmcnt(8)
  v_mfma_f32_32x32x16_bf16 v[240:255], v[12:15], v[20:23], v[240:255]
  ds_read_b64_tr_b16 v[48:49], v16 offset:4096
  ds_read_b64_tr_b16 v[50:51], v16 offset:5120
  v_exp_f32 v232, v232
  v_exp_f32 v233, v233
  v_mfma_f32_16x16x32_bf16 v[24:27], v[8:11], v[212:215], v[24:27]
  ds_read_b64_tr_b16 v[52:53], v17 offset:4096
  v_exp_f32 v234, v234
  v_exp_f32 v235, v235
  v_mfma_f32_32x32x16_bf16 v[64:79], v[136:139], v[212:215], v[64:79]
  ds_read_b64_tr_b16 v[54:55], v17 offset:5120
  v_exp_f32 v236, v236
  v_exp_f32 v237, v237
  v_mfma_f32_32x32x16_bf16 v[80:95], v[140:143], v[212:215], v[80:95]
  ds_read_b64_tr_b16 v[56:57], v18 offset:4096
  ds_read_b64_tr_b16 v[58:59], v18 offset:5120
  v_exp_f32 v238, v238
  v_exp_f32 v239, v239
  v_mfma_f32_32x32x16_bf16 v[96:111], v[4:7], v[212:215], v[96:111]
  ds_read_b64_tr_b16 v[60:61], v19 offset:4096
  v_cvt_pk_bf16_f32 v228, v232, v233
  v_cvt_pk_bf16_f32 v229, v234, v235
  v_mfma_f32_32x32x16_bf16 v[112:127], v[28:31], v[212:215], v[112:127]
  ds_read_b64_tr_b16 v[62:63], v19 offset:5120
  v_cvt_pk_bf16_f32 v230, v236, v237
  v_cvt_pk_bf16_f32 v231, v238, v239
  s_waitcnt lgkmcnt(8)
  s_barrier
  v_mfma_f32_16x16x32_bf16 v[24:27], v[8:11], v[224:227], v[24:27]
  ds_read_b64_tr_b16 v[136:137], v16 offset:16384
  ds_read_b64_tr_b16 v[138:139], v16 offset:17408
  v_exp_f32 v240, v240
  v_exp_f32 v241, v241
  v_mfma_f32_32x32x16_bf16 v[64:79], v[32:35], v[224:227], v[64:79]
  ds_read_b64_tr_b16 v[140:141], v17 offset:16384
  ds_read_b64_tr_b16 v[142:143], v17 offset:17408
  v_exp_f32 v242, v242
  v_exp_f32 v243, v243
  v_exp_f32 v244, v244
  v_mfma_f32_32x32x16_bf16 v[80:95], v[36:39], v[224:227], v[80:95]
  ds_read_b64_tr_b16 v[4:5], v18 offset:16384
  v_exp_f32 v245, v245
  v_exp_f32 v246, v246
  v_mfma_f32_32x32x16_bf16 v[96:111], v[40:43], v[224:227], v[96:111]
  ds_read_b64_tr_b16 v[6:7], v18 offset:17408
  ds_read_b64_tr_b16 v[28:29], v19 offset:16384
  v_exp_f32 v247, v247
  v_cvt_pk_bf16_f32 v240, v240, v241
  v_cvt_pk_bf16_f32 v241, v242, v243
  v_mfma_f32_32x32x16_bf16 v[112:127], v[44:47], v[224:227], v[112:127]
  ds_read_b64_tr_b16 v[30:31], v19 offset:17408
  v_cvt_pk_bf16_f32 v242, v244, v245
  v_cvt_pk_bf16_f32 v243, v246, v247
  s_waitcnt lgkmcnt(8)
  v_mfma_f32_16x16x32_bf16 v[24:27], v[8:11], v[228:231], v[24:27]
  ds_read_b64_tr_b16 v[32:33], v16 offset:20480
  ds_read_b64_tr_b16 v[34:35], v16 offset:21504
  v_exp_f32 v248, v248
  v_exp_f32 v249, v249
  v_mfma_f32_32x32x16_bf16 v[64:79], v[48:51], v[228:231], v[64:79]
  ds_read_b64_tr_b16 v[36:37], v17 offset:20480
  ds_read_b64_tr_b16 v[38:39], v17 offset:21504
  v_exp_f32 v250, v250
  v_exp_f32 v251, v251
  v_exp_f32 v252, v252
  v_mfma_f32_32x32x16_bf16 v[80:95], v[52:55], v[228:231], v[80:95]
  ds_read_b64_tr_b16 v[40:41], v18 offset:20480
  v_exp_f32 v253, v253
  v_exp_f32 v254, v254
  v_mfma_f32_32x32x16_bf16 v[96:111], v[56:59], v[228:231], v[96:111]
  ds_read_b64_tr_b16 v[42:43], v18 offset:21504
  ds_read_b64_tr_b16 v[44:45], v19 offset:20480
  v_exp_f32 v255, v255
  v_cvt_pk_bf16_f32 v244, v248, v249
  v_cvt_pk_bf16_f32 v245, v250, v251
  v_mfma_f32_32x32x16_bf16 v[112:127], v[60:63], v[228:231], v[112:127]
  ds_read_b64_tr_b16 v[46:47], v19 offset:21504
  v_cvt_pk_bf16_f32 v246, v252, v253
  v_cvt_pk_bf16_f32 v247, v254, v255
  s_waitcnt lgkmcnt(0)
  s_barrier
  v_mfma_f32_16x16x32_bf16 v[24:27], v[8:11], v[240:243], v[24:27]
  v_mfma_f32_32x32x16_bf16 v[64:79], v[136:139], v[240:243], v[64:79]
  v_mfma_f32_32x32x16_bf16 v[80:95], v[140:143], v[240:243], v[80:95]
  v_mfma_f32_32x32x16_bf16 v[96:111], v[4:7], v[240:243], v[96:111]
  v_mfma_f32_32x32x16_bf16 v[112:127], v[28:31], v[240:243], v[112:127]
  v_mfma_f32_16x16x32_bf16 v[24:27], v[8:11], v[244:247], v[24:27]
  v_mfma_f32_32x32x16_bf16 v[64:79], v[32:35], v[244:247], v[64:79]
  v_mfma_f32_32x32x16_bf16 v[80:95], v[36:39], v[244:247], v[80:95]
  v_mfma_f32_32x32x16_bf16 v[96:111], v[40:43], v[244:247], v[96:111]
  v_mfma_f32_32x32x16_bf16 v[112:127], v[44:47], v[244:247], v[112:127]
  s_lshl_b32 s24, s23, 9
  s_add_u32 s24, s24, 49152
  v_lshl_add_u32 v16, v1, 2, s24
  s_mov_b64 exec, 0xffffffff
  ds_write_b32 v16, v3
  s_mov_b64 exec, 0xffff
  ds_write_b32 v16, v24 offset:128
  ds_write_b32 v16, v25 offset:192
  s_mov_b64 exec, -1
  s_lshl_b32 s24, s23, 13
  s_add_u32 s24, s24, 0
  v_lshl_add_u32 v17, v1, 4, s24
  ds_write_b128 v17, v[96:99]
  ds_write_b128 v17, v[100:103] offset:1024
  ds_write_b128 v17, v[104:107] offset:2048
  ds_write_b128 v17, v[108:111] offset:3072
  ds_write_b128 v17, v[112:115] offset:4096
  ds_write_b128 v17, v[116:119] offset:5120
  ds_write_b128 v17, v[120:123] offset:6144
  ds_write_b128 v17, v[124:127] offset:7168
  s_waitcnt lgkmcnt(0)
  s_barrier
  s_xor_b32 s26, s23, 2
  s_lshl_b32 s24, s26, 9
  s_add_u32 s24, s24, 49152
  v_and_b32 v18, 31, v1
  v_lshl_add_u32 v16, v18, 2, s24
  ds_read_b32 v22, v16
  ds_read_b32 v23, v16 offset:128
  s_lshl_b32 s24, s23, 9
  s_add_u32 s24, s24, 49280
  v_lshl_add_u32 v16, v18, 2, s24
  ds_read_b32 v21, v16
  v_mov_b32 v20, v3
  s_lshl_b32 s24, s26, 13
  s_add_u32 s24, s24, 0
  v_lshl_add_u32 v17, v1, 4, s24
  ds_read_b128 v[160:163], v17
  ds_read_b128 v[164:167], v17 offset:1024
  ds_read_b128 v[168:171], v17 offset:2048
  ds_read_b128 v[172:175], v17 offset:3072
  ds_read_b128 v[176:179], v17 offset:4096
  ds_read_b128 v[180:183], v17 offset:5120
  ds_read_b128 v[184:187], v17 offset:6144
  ds_read_b128 v[188:191], v17 offset:7168
  s_waitcnt lgkmcnt(8)
  v_max_f32 v24, v20, v22
  v_sub_f32 v25, v20, v24
  v_sub_f32 v26, v22, v24
  v_exp_f32 v25, v25
  v_exp_f32 v26, v26
  v_mul_f32 v27, v25, v21
  v_fma_f32 v27, v26, v23, v27
  v_rcp_f32 v27, v27
  s_nop 0
  v_mul_f32 v25, v25, v27
  v_mul_f32 v26, v26, v27
  v_mov_b32 v28, v25
  v_mov_b32 v29, v25
  v_mov_b32 v30, v26
  v_mov_b32 v31, v26
  v_pk_mul_f32 v[64:65], v[64:65], v[28:29]
  v_pk_mul_f32 v[66:67], v[66:67], v[28:29]
  v_pk_mul_f32 v[68:69], v[68:69], v[28:29]
  v_pk_mul_f32 v[70:71], v[70:71], v[28:29]
  v_pk_mul_f32 v[72:73], v[72:73], v[28:29]
  v_pk_mul_f32 v[74:75], v[74:75], v[28:29]
  v_pk_mul_f32 v[76:77], v[76:77], v[28:29]
  v_pk_mul_f32 v[78:79], v[78:79], v[28:29]
  v_pk_mul_f32 v[80:81], v[80:81], v[28:29]
  v_pk_mul_f32 v[82:83], v[82:83], v[28:29]
  v_pk_mul_f32 v[84:85], v[84:85], v[28:29]
  v_pk_mul_f32 v[86:87], v[86:87], v[28:29]
  v_pk_mul_f32 v[88:89], v[88:89], v[28:29]
  v_pk_mul_f32 v[90:91], v[90:91], v[28:29]
  v_pk_mul_f32 v[92:93], v[92:93], v[28:29]
  v_pk_mul_f32 v[94:95], v[94:95], v[28:29]
  s_waitcnt lgkmcnt(0)
  v_pk_fma_f32 v[64:65], v[160:161], v[30:31], v[64:65]
  v_pk_fma_f32 v[66:67], v[162:163], v[30:31], v[66:67]
  v_pk_fma_f32 v[68:69], v[164:165], v[30:31], v[68:69]
  v_pk_fma_f32 v[70:71], v[166:167], v[30:31], v[70:71]
  v_pk_fma_f32 v[72:73], v[168:169], v[30:31], v[72:73]
  v_pk_fma_f32 v[74:75], v[170:171], v[30:31], v[74:75]
  v_pk_fma_f32 v[76:77], v[172:173], v[30:31], v[76:77]
  v_pk_fma_f32 v[78:79], v[174:175], v[30:31], v[78:79]
  v_pk_fma_f32 v[80:81], v[176:177], v[30:31], v[80:81]
  v_pk_fma_f32 v[82:83], v[178:179], v[30:31], v[82:83]
  v_pk_fma_f32 v[84:85], v[180:181], v[30:31], v[84:85]
  v_pk_fma_f32 v[86:87], v[182:183], v[30:31], v[86:87]
  v_pk_fma_f32 v[88:89], v[184:185], v[30:31], v[88:89]
  v_pk_fma_f32 v[90:91], v[186:187], v[30:31], v[90:91]
  v_pk_fma_f32 v[92:93], v[188:189], v[30:31], v[92:93]
  v_pk_fma_f32 v[94:95], v[190:191], v[30:31], v[94:95]
  s_mov_b32 s25, 4194304
  s_add_u32 s52, s18, s25
  s_addc_u32 s53, s19, 0
  s_mov_b32 s54, 4194304
  s_mov_b32 s55, 0x20000
  s_lshl_b32 s24, s28, 12
  s_add_u32 s24, s24, s78
  v_cvt_pk_bf16_f32 v128, v64, v65
  v_cvt_pk_bf16_f32 v129, v66, v67
  v_cvt_pk_bf16_f32 v130, v68, v69
  v_cvt_pk_bf16_f32 v131, v70, v71
  buffer_store_dwordx4 v[128:131], v2, s[52:55], s24 offen sc1
  v_cvt_pk_bf16_f32 v132, v72, v73
  v_cvt_pk_bf16_f32 v133, v74, v75
  v_cvt_pk_bf16_f32 v134, v76, v77
  v_cvt_pk_bf16_f32 v135, v78, v79
  buffer_store_dwordx4 v[132:135], v2, s[52:55], s24 offen offset:1024 sc1
  v_cvt_pk_bf16_f32 v136, v80, v81
  v_cvt_pk_bf16_f32 v137, v82, v83
  v_cvt_pk_bf16_f32 v138, v84, v85
  v_cvt_pk_bf16_f32 v139, v86, v87
  buffer_store_dwordx4 v[136:139], v2, s[52:55], s24 offen offset:2048 sc1
  v_cvt_pk_bf16_f32 v140, v88, v89
  v_cvt_pk_bf16_f32 v141, v90, v91
  v_cvt_pk_bf16_f32 v142, v92, v93
  v_cvt_pk_bf16_f32 v143, v94, v95
  buffer_store_dwordx4 v[140:143], v2, s[52:55], s24 offen offset:3072 sc1
  s_waitcnt vmcnt(0)
  s_barrier
  v_mov_b32 v60, s82
  v_mov_b32 v61, 0
  s_cmp_lg_u32 s23, 0
  s_cbranch_scc1 standalone__gqa_block_cached__near_ridge_kernel_nofl_21
  s_lshl_b32 s24, s29, 7
  s_add_u32 s24, s24, 65536
  s_mov_b64 exec, 1
  s_cmp_eq_u32 s8, 0
  s_cbranch_scc1 standalone__gqa_block_cached__near_ridge_kernel_loc_22
  buffer_store_dword v60, v61, s[68:71], s24 offen
standalone__gqa_block_cached__near_ridge_kernel_locj_23:
  s_mov_b64 exec, -1
standalone__gqa_block_cached__near_ridge_kernel_nofl_21:
  s_cmp_lg_u32 s23, 0
  s_cbranch_scc1 standalone__gqa_block_cached__near_ridge_kernel_nopoll0_24
  s_and_b32 s1, s29, 248
  s_lshl_b32 s1, s1, 7
  s_add_u32 s1, s1, 65536
  v_lshlrev_b32 v62, 7, v1
  s_mov_b64 exec, 255
  buffer_load_dword v59, v62, s[68:71], s1 offen sc1
  s_mov_b64 exec, -1
standalone__gqa_block_cached__near_ridge_kernel_nopoll0_24:
  s_lshl_b32 s75, s28, 3
  s_add_u32 s76, s75, 4
  v_and_b32 v3, 15, v1
  v_lshrrev_b32 v4, 2, v3
  v_lshrrev_b32 v5, 5, v1
  v_lshl_add_u32 v5, v5, 3, v4
  v_lshlrev_b32 v5, 8, v5
  v_bfe_u32 v7, v3, 1, 1
  v_lshl_add_u32 v5, v7, 3, v5
  v_and_b32 v6, 1, v3
  v_bfe_u32 v7, v1, 4, 1
  v_lshl_add_u32 v6, v7, 1, v6
  v_lshlrev_b32 v4, 2, v4
  v_add_u32 v7, s75, v6
  v_xor_b32 v7, v7, v4
  v_lshl_add_u32 v8, v7, 4, v5
  v_add_u32 v7, s76, v6
  v_xor_b32 v7, v7, v4
  v_lshl_add_u32 v9, v7, 4, v5
  v_add_u32 v10, 65536, v8
  v_add_u32 v13, 131072, v8
  v_add_u32 v11, 65536, v9
  v_add_u32 v14, 131072, v9
  s_lshl_b32 s24, s27, 12
  s_add_u32 s24, s24, 0
  v_lshl_add_u32 v12, v1, 4, s24
  v_mov_b32 v16, 0
  v_mov_b32 v17, 0
  v_mov_b32 v18, 0
  v_mov_b32 v19, 0
  v_mov_b32 v20, 0
  v_mov_b32 v21, 0
  v_mov_b32 v22, 0
  v_mov_b32 v23, 0
  v_mov_b32 v24, 0
  v_mov_b32 v25, 0
  v_mov_b32 v26, 0
  v_mov_b32 v27, 0
  v_mov_b32 v28, 0
  v_mov_b32 v29, 0
  v_mov_b32 v30, 0
  v_mov_b32 v31, 0
  v_mov_b32 v32, 0
  v_mov_b32 v33, 0
  v_mov_b32 v34, 0
  v_mov_b32 v35, 0
  v_mov_b32 v36, 0
  v_mov_b32 v37, 0
  v_mov_b32 v38, 0
  v_mov_b32 v39, 0
  v_mov_b32 v40, 0
  v_mov_b32 v41, 0
  v_mov_b32 v42, 0
  v_mov_b32 v43, 0
  v_mov_b32 v44, 0
  v_mov_b32 v45, 0
  v_mov_b32 v46, 0
  v_mov_b32 v47, 0
  s_lshl_b32 s24, s21, 3
  s_add_u32 s24, s24, s22
  s_lshl_b32 s24, s24, 17
  s_add_u32 s24, s24, 8388608
  s_add_u32 s60, s18, s24
  s_addc_u32 s61, s19, 0
  s_mov_b32 s62, 131072
  s_mov_b32 s63, 0x20000
  s_lshl_b32 s74, s20, 15
  s_lshl_b32 s24, s23, 11
  s_add_u32 s74, s74, s24
  s_lshl_b32 s24, s21, 1
  s_add_u32 s24, s24, s27
  s_lshl_b32 s79, s24, 16
  s_add_u32 s25, s22, 2
  s_and_b32 s25, s25, 7
  s_lshl_b32 s25, s25, 8
  s_add_u32 s79, s79, s25
  s_lshl_b32 s25, s28, 7
  s_add_u32 s79, s79, s25
  s_lshl_b32 s25, s20, 5
  s_add_u32 s79, s79, s25
  v_and_b32 v3, 31, v1
  v_lshlrev_b32 v3, 11, v3
  v_lshrrev_b32 v4, 5, v1
  v_lshl_add_u32 v3, v4, 4, v3
  s_mov_b32 s64, s14
  s_mov_b32 s65, s15
  s_mov_b32 s66, 1048576
  s_mov_b32 s67, 0x20000
  s_add_u32 s24, s20, 1
  s_and_b32 s24, s24, 3
  s_lshl_b32 s24, s24, 15
  s_lshl_b32 s25, s20, 13
  s_add_u32 s24, s24, s25
  s_lshl_b32 s25, s23, 11
  s_add_u32 s75, s24, s25
  s_add_u32 s24, s20, 2
  s_and_b32 s24, s24, 3
  s_lshl_b32 s24, s24, 15
  s_lshl_b32 s25, s20, 13
  s_add_u32 s24, s24, s25
  s_lshl_b32 s25, s23, 11
  s_add_u32 s76, s24, s25
  s_add_u32 s24, s20, 3
  s_and_b32 s24, s24, 3
  s_lshl_b32 s24, s24, 15
  s_lshl_b32 s25, s20, 13
  s_add_u32 s24, s24, s25
  s_lshl_b32 s25, s23, 11
  s_add_u32 s77, s24, s25
  s_lshl_b32 s24, s21, 5
  s_add_u32 s24, s24, s22
  s_lshl_b32 s5, s24, 7
  s_add_u32 s5, s5, 98304
  v_lshlrev_b32 v63, 10, v1
  v_mov_b32 v60, s82
  v_mov_b32 v61, 0
  s_cmp_lg_u32 s23, 0
  s_cbranch_scc1 standalone__gqa_block_cached__near_ridge_kernel_nopoll_25
  s_mov_b64 exec, 255
  s_mov_b32 s30, 0
standalone__gqa_block_cached__near_ridge_kernel_poll_26:
  s_waitcnt vmcnt(0)
  v_cmp_ne_u32 vcc, s82, v59
  s_add_u32 s30, s30, 1
  s_cbranch_vccz standalone__gqa_block_cached__near_ridge_kernel_pdone_27
  s_sleep 1
  buffer_load_dword v59, v62, s[68:71], s1 offen sc1
  s_cmp_lt_u32 s30, 40000
  s_cbranch_scc1 standalone__gqa_block_cached__near_ridge_kernel_poll_26
  s_waitcnt vmcnt(0)
standalone__gqa_block_cached__near_ridge_kernel_pdone_27:
  s_mov_b64 exec, -1
standalone__gqa_block_cached__near_ridge_kernel_nopoll_25:
  s_barrier
  s_barrier
  ds_read_b128 v[64:67], v12
  ds_read_b64_tr_b16 v[80:81], v10
  ds_read_b64_tr_b16 v[82:83], v10 offset:1024
  ds_read_b64_tr_b16 v[96:97], v11
  ds_read_b64_tr_b16 v[98:99], v11 offset:1024
  ds_read_b128 v[68:71], v12 offset:1024
  ds_read_b64_tr_b16 v[84:85], v10 offset:4096
  ds_read_b64_tr_b16 v[86:87], v10 offset:5120
  ds_read_b64_tr_b16 v[100:101], v11 offset:4096
  ds_read_b64_tr_b16 v[102:103], v11 offset:5120
  ds_read_b128 v[72:75], v12 offset:2048
  ds_read_b64_tr_b16 v[88:89], v10 offset:8192
  ds_read_b64_tr_b16 v[90:91], v10 offset:9216
  ds_read_b64_tr_b16 v[104:105], v11 offset:8192
  ds_read_b64_tr_b16 v[106:107], v11 offset:9216
  ds_read_b128 v[76:79], v12 offset:3072
  ds_read_b64_tr_b16 v[92:93], v10 offset:12288
  ds_read_b64_tr_b16 v[94:95], v10 offset:13312
  ds_read_b64_tr_b16 v[108:109], v11 offset:12288
  ds_read_b64_tr_b16 v[110:111], v11 offset:13312
  s_waitcnt lgkmcnt(0)
  s_barrier
  v_mfma_f32_32x32x16_bf16 v[16:31], v[80:83], v[64:67], v[16:31]
  ds_read_b128 v[112:115], v12 offset:8192
  ds_read_b64_tr_b16 v[128:129], v10 offset:16384
  ds_read_b64_tr_b16 v[130:131], v10 offset:17408
  ds_read_b64_tr_b16 v[144:145], v11 offset:16384
  v_mfma_f32_32x32x16_bf16 v[32:47], v[96:99], v[64:67], v[32:47]
  ds_read_b64_tr_b16 v[146:147], v11 offset:17408
  ds_read_b128 v[116:119], v12 offset:9216
  ds_read_b64_tr_b16 v[132:133], v10 offset:20480
  v_mfma_f32_32x32x16_bf16 v[16:31], v[84:87], v[68:71], v[16:31]
  ds_read_b64_tr_b16 v[134:135], v10 offset:21504
  ds_read_b64_tr_b16 v[148:149], v11 offset:20480
  ds_read_b64_tr_b16 v[150:151], v11 offset:21504
  v_mfma_f32_32x32x16_bf16 v[32:47], v[100:103], v[68:71], v[32:47]
  ds_read_b128 v[120:123], v12 offset:10240
  ds_read_b64_tr_b16 v[136:137], v10 offset:24576
  ds_read_b64_tr_b16 v[138:139], v10 offset:25600
  ds_read_b64_tr_b16 v[152:153], v11 offset:24576
  v_mfma_f32_32x32x16_bf16 v[16:31], v[88:91], v[72:75], v[16:31]
  ds_read_b64_tr_b16 v[154:155], v11 offset:25600
  ds_read_b128 v[124:127], v12 offset:11264
  ds_read_b64_tr_b16 v[140:141], v10 offset:28672
  v_mfma_f32_32x32x16_bf16 v[32:47], v[104:107], v[72:75], v[32:47]
  ds_read_b64_tr_b16 v[142:143], v10 offset:29696
  ds_read_b64_tr_b16 v[156:157], v11 offset:28672
  ds_read_b64_tr_b16 v[158:159], v11 offset:29696
  v_mfma_f32_32x32x16_bf16 v[16:31], v[92:95], v[76:79], v[16:31]
  v_mfma_f32_32x32x16_bf16 v[32:47], v[108:111], v[76:79], v[32:47]
  s_waitcnt lgkmcnt(0)
  s_barrier
  v_mfma_f32_32x32x16_bf16 v[16:31], v[128:131], v[112:115], v[16:31]
  ds_read_b128 v[64:67], v12 offset:16384
  ds_read_b64_tr_b16 v[80:81], v10 offset:32768
  ds_read_b64_tr_b16 v[82:83], v10 offset:33792
  ds_read_b64_tr_b16 v[96:97], v11 offset:32768
  v_mfma_f32_32x32x16_bf16 v[32:47], v[144:147], v[112:115], v[32:47]
  ds_read_b64_tr_b16 v[98:99], v11 offset:33792
  ds_read_b128 v[68:71], v12 offset:17408
  ds_read_b64_tr_b16 v[84:85], v10 offset:36864
  v_mfma_f32_32x32x16_bf16 v[16:31], v[132:135], v[116:119], v[16:31]
  ds_read_b64_tr_b16 v[86:87], v10 offset:37888
  ds_read_b64_tr_b16 v[100:101], v11 offset:36864
  ds_read_b64_tr_b16 v[102:103], v11 offset:37888
  v_mfma_f32_32x32x16_bf16 v[32:47], v[148:151], v[116:119], v[32:47]
  ds_read_b128 v[72:75], v12 offset:18432
  ds_read_b64_tr_b16 v[88:89], v10 offset:40960
  ds_read_b64_tr_b16 v[90:91], v10 offset:41984
  ds_read_b64_tr_b16 v[104:105], v11 offset:40960
  v_mfma_f32_32x32x16_bf16 v[16:31], v[136:139], v[120:123], v[16:31]
  ds_read_b64_tr_b16 v[106:107], v11 offset:41984
  ds_read_b128 v[76:79], v12 offset:19456
  ds_read_b64_tr_b16 v[92:93], v10 offset:45056
  v_mfma_f32_32x32x16_bf16 v[32:47], v[152:155], v[120:123], v[32:47]
  ds_read_b64_tr_b16 v[94:95], v10 offset:46080
  ds_read_b64_tr_b16 v[108:109], v11 offset:45056
  ds_read_b64_tr_b16 v[110:111], v11 offset:46080
  v_mfma_f32_32x32x16_bf16 v[16:31], v[140:143], v[124:127], v[16:31]
  v_mfma_f32_32x32x16_bf16 v[32:47], v[156:159], v[124:127], v[32:47]
  s_waitcnt lgkmcnt(0)
  s_barrier
  v_mfma_f32_32x32x16_bf16 v[16:31], v[80:83], v[64:67], v[16:31]
  ds_read_b128 v[112:115], v12 offset:24576
  ds_read_b64_tr_b16 v[128:129], v10 offset:49152
  ds_read_b64_tr_b16 v[130:131], v10 offset:50176
  ds_read_b64_tr_b16 v[144:145], v11 offset:49152
  v_mfma_f32_32x32x16_bf16 v[32:47], v[96:99], v[64:67], v[32:47]
  ds_read_b64_tr_b16 v[146:147], v11 offset:50176
  ds_read_b128 v[116:119], v12 offset:25600
  ds_read_b64_tr_b16 v[132:133], v10 offset:53248
  v_mfma_f32_32x32x16_bf16 v[16:31], v[84:87], v[68:71], v[16:31]
  ds_read_b64_tr_b16 v[134:135], v10 offset:54272
  ds_read_b64_tr_b16 v[148:149], v11 offset:53248
  ds_read_b64_tr_b16 v[150:151], v11 offset:54272
  v_mfma_f32_32x32x16_bf16 v[32:47], v[100:103], v[68:71], v[32:47]
  ds_read_b128 v[120:123], v12 offset:26624
  ds_read_b64_tr_b16 v[136:137], v10 offset:57344
  ds_read_b64_tr_b16 v[138:139], v10 offset:58368
  ds_read_b64_tr_b16 v[152:153], v11 offset:57344
  v_mfma_f32_32x32x16_bf16 v[16:31], v[88:91], v[72:75], v[16:31]
  ds_read_b64_tr_b16 v[154:155], v11 offset:58368
  ds_read_b128 v[124:127], v12 offset:27648
  ds_read_b64_tr_b16 v[140:141], v10 offset:61440
  v_mfma_f32_32x32x16_bf16 v[32:47], v[104:107], v[72:75], v[32:47]
  ds_read_b64_tr_b16 v[142:143], v10 offset:62464
  ds_read_b64_tr_b16 v[156:157], v11 offset:61440
  ds_read_b64_tr_b16 v[158:159], v11 offset:62464
  v_mfma_f32_32x32x16_bf16 v[16:31], v[92:95], v[76:79], v[16:31]
  v_mfma_f32_32x32x16_bf16 v[32:47], v[108:111], v[76:79], v[32:47]
  s_waitcnt lgkmcnt(0)
  s_barrier
  v_mfma_f32_32x32x16_bf16 v[16:31], v[128:131], v[112:115], v[16:31]
  ds_read_b128 v[64:67], v12
  ds_read_b64_tr_b16 v[80:81], v13
  ds_read_b64_tr_b16 v[82:83], v13 offset:1024
  ds_read_b64_tr_b16 v[96:97], v14
  v_mfma_f32_32x32x16_bf16 v[32:47], v[144:147], v[112:115], v[32:47]
  ds_read_b64_tr_b16 v[98:99], v14 offset:1024
  ds_read_b128 v[68:71], v12 offset:1024
  ds_read_b64_tr_b16 v[84:85], v13 offset:4096
  v_mfma_f32_32x32x16_bf16 v[16:31], v[132:135], v[116:119], v[16:31]
  ds_read_b64_tr_b16 v[86:87], v13 offset:5120
  ds_read_b64_tr_b16 v[100:101], v14 offset:4096
  ds_read_b64_tr_b16 v[102:103], v14 offset:5120
  v_mfma_f32_32x32x16_bf16 v[32:47], v[148:151], v[116:119], v[32:47]
  ds_read_b128 v[72:75], v12 offset:2048
  ds_read_b64_tr_b16 v[88:89], v13 offset:8192
  ds_read_b64_tr_b16 v[90:91], v13 offset:9216
  ds_read_b64_tr_b16 v[104:105], v14 offset:8192
  v_mfma_f32_32x32x16_bf16 v[16:31], v[136:139], v[120:123], v[16:31]
  ds_read_b64_tr_b16 v[106:107], v14 offset:9216
  ds_read_b128 v[76:79], v12 offset:3072
  ds_read_b64_tr_b16 v[92:93], v13 offset:12288
  v_mfma_f32_32x32x16_bf16 v[32:47], v[152:155], v[120:123], v[32:47]
  ds_read_b64_tr_b16 v[94:95], v13 offset:13312
  ds_read_b64_tr_b16 v[108:109], v14 offset:12288
  ds_read_b64_tr_b16 v[110:111], v14 offset:13312
  v_mfma_f32_32x32x16_bf16 v[16:31], v[140:143], v[124:127], v[16:31]
  v_mfma_f32_32x32x16_bf16 v[32:47], v[156:159], v[124:127], v[32:47]
  s_waitcnt lgkmcnt(0)
  s_barrier
  v_mfma_f32_32x32x16_bf16 v[16:31], v[80:83], v[64:67], v[16:31]
  ds_read_b128 v[112:115], v12 offset:8192
  ds_read_b64_tr_b16 v[128:129], v13 offset:16384
  ds_read_b64_tr_b16 v[130:131], v13 offset:17408
  ds_read_b64_tr_b16 v[144:145], v14 offset:16384
  v_mfma_f32_32x32x16_bf16 v[32:47], v[96:99], v[64:67], v[32:47]
  ds_read_b64_tr_b16 v[146:147], v14 offset:17408
  ds_read_b128 v[116:119], v12 offset:9216
  ds_read_b64_tr_b16 v[132:133], v13 offset:20480
  v_mfma_f32_32x32x16_bf16 v[16:31], v[84:87], v[68:71], v[16:31]
  ds_read_b64_tr_b16 v[134:135], v13 offset:21504
  ds_read_b64_tr_b16 v[148:149], v14 offset:20480
  ds_read_b64_tr_b16 v[150:151], v14 offset:21504
  v_mfma_f32_32x32x16_bf16 v[32:47], v[100:103], v[68:71], v[32:47]
  ds_read_b128 v[120:123], v12 offset:10240
  ds_read_b64_tr_b16 v[136:137], v13 offset:24576
  ds_read_b64_tr_b16 v[138:139], v13 offset:25600
  ds_read_b64_tr_b16 v[152:153], v14 offset:24576
  v_mfma_f32_32x32x16_bf16 v[16:31], v[88:91], v[72:75], v[16:31]
  ds_read_b64_tr_b16 v[154:155], v14 offset:25600
  ds_read_b128 v[124:127], v12 offset:11264
  ds_read_b64_tr_b16 v[140:141], v13 offset:28672
  v_mfma_f32_32x32x16_bf16 v[32:47], v[104:107], v[72:75], v[32:47]
  ds_read_b64_tr_b16 v[142:143], v13 offset:29696
  ds_read_b64_tr_b16 v[156:157], v14 offset:28672
  ds_read_b64_tr_b16 v[158:159], v14 offset:29696
  v_mfma_f32_32x32x16_bf16 v[16:31], v[92:95], v[76:79], v[16:31]
  v_mfma_f32_32x32x16_bf16 v[32:47], v[108:111], v[76:79], v[32:47]
  s_waitcnt lgkmcnt(0)
  s_barrier
  v_mfma_f32_32x32x16_bf16 v[16:31], v[128:131], v[112:115], v[16:31]
  ds_read_b128 v[64:67], v12 offset:16384
  ds_read_b64_tr_b16 v[80:81], v8 offset:32768
  ds_read_b64_tr_b16 v[82:83], v8 offset:33792
  ds_read_b64_tr_b16 v[96:97], v9 offset:32768
  v_mfma_f32_32x32x16_bf16 v[32:47], v[144:147], v[112:115], v[32:47]
  ds_read_b64_tr_b16 v[98:99], v9 offset:33792
  ds_read_b128 v[68:71], v12 offset:17408
  ds_read_b64_tr_b16 v[84:85], v8 offset:36864
  v_mfma_f32_32x32x16_bf16 v[16:31], v[132:135], v[116:119], v[16:31]
  ds_read_b64_tr_b16 v[86:87], v8 offset:37888
  ds_read_b64_tr_b16 v[100:101], v9 offset:36864
  ds_read_b64_tr_b16 v[102:103], v9 offset:37888
  v_mfma_f32_32x32x16_bf16 v[32:47], v[148:151], v[116:119], v[32:47]
  ds_read_b128 v[72:75], v12 offset:18432
  ds_read_b64_tr_b16 v[88:89], v8 offset:40960
  ds_read_b64_tr_b16 v[90:91], v8 offset:41984
  ds_read_b64_tr_b16 v[104:105], v9 offset:40960
  v_mfma_f32_32x32x16_bf16 v[16:31], v[136:139], v[120:123], v[16:31]
  ds_read_b64_tr_b16 v[106:107], v9 offset:41984
  ds_read_b128 v[76:79], v12 offset:19456
  ds_read_b64_tr_b16 v[92:93], v8 offset:45056
  v_mfma_f32_32x32x16_bf16 v[32:47], v[152:155], v[120:123], v[32:47]
  ds_read_b64_tr_b16 v[94:95], v8 offset:46080
  ds_read_b64_tr_b16 v[108:109], v9 offset:45056
  ds_read_b64_tr_b16 v[110:111], v9 offset:46080
  v_mfma_f32_32x32x16_bf16 v[16:31], v[140:143], v[124:127], v[16:31]
  v_mfma_f32_32x32x16_bf16 v[32:47], v[156:159], v[124:127], v[32:47]
  s_waitcnt lgkmcnt(0)
  s_barrier
  v_mfma_f32_32x32x16_bf16 v[16:31], v[80:83], v[64:67], v[16:31]
  ds_read_b128 v[112:115], v12 offset:24576
  ds_read_b64_tr_b16 v[128:129], v8 offset:49152
  ds_read_b64_tr_b16 v[130:131], v8 offset:50176
  ds_read_b64_tr_b16 v[144:145], v9 offset:49152
  v_mfma_f32_32x32x16_bf16 v[32:47], v[96:99], v[64:67], v[32:47]
  ds_read_b64_tr_b16 v[146:147], v9 offset:50176
  ds_read_b128 v[116:119], v12 offset:25600
  ds_read_b64_tr_b16 v[132:133], v8 offset:53248
  v_mfma_f32_32x32x16_bf16 v[16:31], v[84:87], v[68:71], v[16:31]
  ds_read_b64_tr_b16 v[134:135], v8 offset:54272
  ds_read_b64_tr_b16 v[148:149], v9 offset:53248
  ds_read_b64_tr_b16 v[150:151], v9 offset:54272
  v_mfma_f32_32x32x16_bf16 v[32:47], v[100:103], v[68:71], v[32:47]
  ds_read_b128 v[120:123], v12 offset:26624
  ds_read_b64_tr_b16 v[136:137], v8 offset:57344
  ds_read_b64_tr_b16 v[138:139], v8 offset:58368
  ds_read_b64_tr_b16 v[152:153], v9 offset:57344
  v_mfma_f32_32x32x16_bf16 v[16:31], v[88:91], v[72:75], v[16:31]
  ds_read_b64_tr_b16 v[154:155], v9 offset:58368
  ds_read_b128 v[124:127], v12 offset:27648
  ds_read_b64_tr_b16 v[140:141], v8 offset:61440
  v_mfma_f32_32x32x16_bf16 v[32:47], v[104:107], v[72:75], v[32:47]
  ds_read_b64_tr_b16 v[142:143], v8 offset:62464
  ds_read_b64_tr_b16 v[156:157], v9 offset:61440
  ds_read_b64_tr_b16 v[158:159], v9 offset:62464
  v_mfma_f32_32x32x16_bf16 v[16:31], v[92:95], v[76:79], v[16:31]
  v_mfma_f32_32x32x16_bf16 v[32:47], v[108:111], v[76:79], v[32:47]
  s_waitcnt lgkmcnt(0)
  s_barrier
  v_mfma_f32_32x32x16_bf16 v[16:31], v[128:131], v[112:115], v[16:31]
  ds_read_b128 v[64:67], v12
  ds_read_b64_tr_b16 v[80:81], v10
  ds_read_b64_tr_b16 v[82:83], v10 offset:1024
  ds_read_b64_tr_b16 v[96:97], v11
  v_mfma_f32_32x32x16_bf16 v[32:47], v[144:147], v[112:115], v[32:47]
  ds_read_b64_tr_b16 v[98:99], v11 offset:1024
  ds_read_b128 v[68:71], v12 offset:1024
  ds_read_b64_tr_b16 v[84:85], v10 offset:4096
  v_mfma_f32_32x32x16_bf16 v[16:31], v[132:135], v[116:119], v[16:31]
  ds_read_b64_tr_b16 v[86:87], v10 offset:5120
  ds_read_b64_tr_b16 v[100:101], v11 offset:4096
  ds_read_b64_tr_b16 v[102:103], v11 offset:5120
  v_mfma_f32_32x32x16_bf16 v[32:47], v[148:151], v[116:119], v[32:47]
  ds_read_b128 v[72:75], v12 offset:2048
  ds_read_b64_tr_b16 v[88:89], v10 offset:8192
  ds_read_b64_tr_b16 v[90:91], v10 offset:9216
  ds_read_b64_tr_b16 v[104:105], v11 offset:8192
  v_mfma_f32_32x32x16_bf16 v[16:31], v[136:139], v[120:123], v[16:31]
  ds_read_b64_tr_b16 v[106:107], v11 offset:9216
  ds_read_b128 v[76:79], v12 offset:3072
  ds_read_b64_tr_b16 v[92:93], v10 offset:12288
  v_mfma_f32_32x32x16_bf16 v[32:47], v[152:155], v[120:123], v[32:47]
  ds_read_b64_tr_b16 v[94:95], v10 offset:13312
  ds_read_b64_tr_b16 v[108:109], v11 offset:12288
  ds_read_b64_tr_b16 v[110:111], v11 offset:13312
  v_mfma_f32_32x32x16_bf16 v[16:31], v[140:143], v[124:127], v[16:31]
  v_mfma_f32_32x32x16_bf16 v[32:47], v[156:159], v[124:127], v[32:47]
  s_waitcnt lgkmcnt(0)
  s_barrier
  v_mfma_f32_32x32x16_bf16 v[16:31], v[80:83], v[64:67], v[16:31]
  ds_read_b128 v[112:115], v12 offset:8192
  ds_read_b64_tr_b16 v[128:129], v10 offset:16384
  ds_read_b64_tr_b16 v[130:131], v10 offset:17408
  ds_read_b64_tr_b16 v[144:145], v11 offset:16384
  v_mfma_f32_32x32x16_bf16 v[32:47], v[96:99], v[64:67], v[32:47]
  ds_read_b64_tr_b16 v[146:147], v11 offset:17408
  ds_read_b128 v[116:119], v12 offset:9216
  ds_read_b64_tr_b16 v[132:133], v10 offset:20480
  v_mfma_f32_32x32x16_bf16 v[16:31], v[84:87], v[68:71], v[16:31]
  ds_read_b64_tr_b16 v[134:135], v10 offset:21504
  ds_read_b64_tr_b16 v[148:149], v11 offset:20480
  ds_read_b64_tr_b16 v[150:151], v11 offset:21504
  v_mfma_f32_32x32x16_bf16 v[32:47], v[100:103], v[68:71], v[32:47]
  ds_read_b128 v[120:123], v12 offset:10240
  ds_read_b64_tr_b16 v[136:137], v10 offset:24576
  ds_read_b64_tr_b16 v[138:139], v10 offset:25600
  ds_read_b64_tr_b16 v[152:153], v11 offset:24576
  v_mfma_f32_32x32x16_bf16 v[16:31], v[88:91], v[72:75], v[16:31]
  ds_read_b64_tr_b16 v[154:155], v11 offset:25600
  ds_read_b128 v[124:127], v12 offset:11264
  ds_read_b64_tr_b16 v[140:141], v10 offset:28672
  v_mfma_f32_32x32x16_bf16 v[32:47], v[104:107], v[72:75], v[32:47]
  ds_read_b64_tr_b16 v[142:143], v10 offset:29696
  ds_read_b64_tr_b16 v[156:157], v11 offset:28672
  ds_read_b64_tr_b16 v[158:159], v11 offset:29696
  v_mfma_f32_32x32x16_bf16 v[16:31], v[92:95], v[76:79], v[16:31]
  v_mfma_f32_32x32x16_bf16 v[32:47], v[108:111], v[76:79], v[32:47]
  s_waitcnt lgkmcnt(0)
  s_barrier
  v_mfma_f32_32x32x16_bf16 v[16:31], v[128:131], v[112:115], v[16:31]
  ds_read_b128 v[64:67], v12 offset:16384
  ds_read_b64_tr_b16 v[80:81], v10 offset:32768
  ds_read_b64_tr_b16 v[82:83], v10 offset:33792
  ds_read_b64_tr_b16 v[96:97], v11 offset:32768
  v_mfma_f32_32x32x16_bf16 v[32:47], v[144:147], v[112:115], v[32:47]
  ds_read_b64_tr_b16 v[98:99], v11 offset:33792
  ds_read_b128 v[68:71], v12 offset:17408
  ds_read_b64_tr_b16 v[84:85], v10 offset:36864
  v_mfma_f32_32x32x16_bf16 v[16:31], v[132:135], v[116:119], v[16:31]
  ds_read_b64_tr_b16 v[86:87], v10 offset:37888
  ds_read_b64_tr_b16 v[100:101], v11 offset:36864
  ds_read_b64_tr_b16 v[102:103], v11 offset:37888
  v_mfma_f32_32x32x16_bf16 v[32:47], v[148:151], v[116:119], v[32:47]
  ds_read_b128 v[72:75], v12 offset:18432
  ds_read_b64_tr_b16 v[88:89], v10 offset:40960
  ds_read_b64_tr_b16 v[90:91], v10 offset:41984
  ds_read_b64_tr_b16 v[104:105], v11 offset:40960
  v_mfma_f32_32x32x16_bf16 v[16:31], v[136:139], v[120:123], v[16:31]
  ds_read_b64_tr_b16 v[106:107], v11 offset:41984
  ds_read_b128 v[76:79], v12 offset:19456
  ds_read_b64_tr_b16 v[92:93], v10 offset:45056
  v_mfma_f32_32x32x16_bf16 v[32:47], v[152:155], v[120:123], v[32:47]
  ds_read_b64_tr_b16 v[94:95], v10 offset:46080
  ds_read_b64_tr_b16 v[108:109], v11 offset:45056
  ds_read_b64_tr_b16 v[110:111], v11 offset:46080
  v_mfma_f32_32x32x16_bf16 v[16:31], v[140:143], v[124:127], v[16:31]
  v_mfma_f32_32x32x16_bf16 v[32:47], v[156:159], v[124:127], v[32:47]
  s_waitcnt lgkmcnt(0)
  s_barrier
  v_mfma_f32_32x32x16_bf16 v[16:31], v[80:83], v[64:67], v[16:31]
  ds_read_b128 v[112:115], v12 offset:24576
  ds_read_b64_tr_b16 v[128:129], v10 offset:49152
  ds_read_b64_tr_b16 v[130:131], v10 offset:50176
  ds_read_b64_tr_b16 v[144:145], v11 offset:49152
  v_mfma_f32_32x32x16_bf16 v[32:47], v[96:99], v[64:67], v[32:47]
  ds_read_b64_tr_b16 v[146:147], v11 offset:50176
  ds_read_b128 v[116:119], v12 offset:25600
  ds_read_b64_tr_b16 v[132:133], v10 offset:53248
  v_mfma_f32_32x32x16_bf16 v[16:31], v[84:87], v[68:71], v[16:31]
  ds_read_b64_tr_b16 v[134:135], v10 offset:54272
  ds_read_b64_tr_b16 v[148:149], v11 offset:53248
  ds_read_b64_tr_b16 v[150:151], v11 offset:54272
  v_mfma_f32_32x32x16_bf16 v[32:47], v[100:103], v[68:71], v[32:47]
  ds_read_b128 v[120:123], v12 offset:26624
  ds_read_b64_tr_b16 v[136:137], v10 offset:57344
  ds_read_b64_tr_b16 v[138:139], v10 offset:58368
  ds_read_b64_tr_b16 v[152:153], v11 offset:57344
  v_mfma_f32_32x32x16_bf16 v[16:31], v[88:91], v[72:75], v[16:31]
  ds_read_b64_tr_b16 v[154:155], v11 offset:58368
  ds_read_b128 v[124:127], v12 offset:27648
  ds_read_b64_tr_b16 v[140:141], v10 offset:61440
  v_mfma_f32_32x32x16_bf16 v[32:47], v[104:107], v[72:75], v[32:47]
  ds_read_b64_tr_b16 v[142:143], v10 offset:62464
  ds_read_b64_tr_b16 v[156:157], v11 offset:61440
  ds_read_b64_tr_b16 v[158:159], v11 offset:62464
  v_mfma_f32_32x32x16_bf16 v[16:31], v[92:95], v[76:79], v[16:31]
  v_mfma_f32_32x32x16_bf16 v[32:47], v[108:111], v[76:79], v[32:47]
  s_waitcnt lgkmcnt(0)
  s_barrier
  v_mfma_f32_32x32x16_bf16 v[16:31], v[128:131], v[112:115], v[16:31]
  ds_read_b128 v[64:67], v12
  ds_read_b64_tr_b16 v[80:81], v13
  ds_read_b64_tr_b16 v[82:83], v13 offset:1024
  ds_read_b64_tr_b16 v[96:97], v14
  v_mfma_f32_32x32x16_bf16 v[32:47], v[144:147], v[112:115], v[32:47]
  ds_read_b64_tr_b16 v[98:99], v14 offset:1024
  ds_read_b128 v[68:71], v12 offset:1024
  ds_read_b64_tr_b16 v[84:85], v13 offset:4096
  v_mfma_f32_32x32x16_bf16 v[16:31], v[132:135], v[116:119], v[16:31]
  ds_read_b64_tr_b16 v[86:87], v13 offset:5120
  ds_read_b64_tr_b16 v[100:101], v14 offset:4096
  ds_read_b64_tr_b16 v[102:103], v14 offset:5120
  v_mfma_f32_32x32x16_bf16 v[32:47], v[148:151], v[116:119], v[32:47]
  ds_read_b128 v[72:75], v12 offset:2048
  ds_read_b64_tr_b16 v[88:89], v13 offset:8192
  ds_read_b64_tr_b16 v[90:91], v13 offset:9216
  ds_read_b64_tr_b16 v[104:105], v14 offset:8192
  v_mfma_f32_32x32x16_bf16 v[16:31], v[136:139], v[120:123], v[16:31]
  ds_read_b64_tr_b16 v[106:107], v14 offset:9216
  ds_read_b128 v[76:79], v12 offset:3072
  ds_read_b64_tr_b16 v[92:93], v13 offset:12288
  v_mfma_f32_32x32x16_bf16 v[32:47], v[152:155], v[120:123], v[32:47]
  ds_read_b64_tr_b16 v[94:95], v13 offset:13312
  ds_read_b64_tr_b16 v[108:109], v14 offset:12288
  ds_read_b64_tr_b16 v[110:111], v14 offset:13312
  v_mfma_f32_32x32x16_bf16 v[16:31], v[140:143], v[124:127], v[16:31]
  v_mfma_f32_32x32x16_bf16 v[32:47], v[156:159], v[124:127], v[32:47]
  s_waitcnt lgkmcnt(0)
  s_barrier
  v_mfma_f32_32x32x16_bf16 v[16:31], v[80:83], v[64:67], v[16:31]
  ds_read_b128 v[112:115], v12 offset:8192
  ds_read_b64_tr_b16 v[128:129], v13 offset:16384
  ds_read_b64_tr_b16 v[130:131], v13 offset:17408
  ds_read_b64_tr_b16 v[144:145], v14 offset:16384
  v_mfma_f32_32x32x16_bf16 v[32:47], v[96:99], v[64:67], v[32:47]
  ds_read_b64_tr_b16 v[146:147], v14 offset:17408
  ds_read_b128 v[116:119], v12 offset:9216
  ds_read_b64_tr_b16 v[132:133], v13 offset:20480
  v_mfma_f32_32x32x16_bf16 v[16:31], v[84:87], v[68:71], v[16:31]
  ds_read_b64_tr_b16 v[134:135], v13 offset:21504
  ds_read_b64_tr_b16 v[148:149], v14 offset:20480
  ds_read_b64_tr_b16 v[150:151], v14 offset:21504
  v_mfma_f32_32x32x16_bf16 v[32:47], v[100:103], v[68:71], v[32:47]
  ds_read_b128 v[120:123], v12 offset:10240
  ds_read_b64_tr_b16 v[136:137], v13 offset:24576
  ds_read_b64_tr_b16 v[138:139], v13 offset:25600
  ds_read_b64_tr_b16 v[152:153], v14 offset:24576
  v_mfma_f32_32x32x16_bf16 v[16:31], v[88:91], v[72:75], v[16:31]
  ds_read_b64_tr_b16 v[154:155], v14 offset:25600
  ds_read_b128 v[124:127], v12 offset:11264
  ds_read_b64_tr_b16 v[140:141], v13 offset:28672
  v_mfma_f32_32x32x16_bf16 v[32:47], v[104:107], v[72:75], v[32:47]
  ds_read_b64_tr_b16 v[142:143], v13 offset:29696
  ds_read_b64_tr_b16 v[156:157], v14 offset:28672
  ds_read_b64_tr_b16 v[158:159], v14 offset:29696
  v_mfma_f32_32x32x16_bf16 v[16:31], v[92:95], v[76:79], v[16:31]
  v_mfma_f32_32x32x16_bf16 v[32:47], v[108:111], v[76:79], v[32:47]
  s_waitcnt lgkmcnt(0)
  s_barrier
  v_mfma_f32_32x32x16_bf16 v[16:31], v[128:131], v[112:115], v[16:31]
  ds_read_b128 v[64:67], v12 offset:16384
  ds_read_b64_tr_b16 v[80:81], v8 offset:32768
  ds_read_b64_tr_b16 v[82:83], v8 offset:33792
  ds_read_b64_tr_b16 v[96:97], v9 offset:32768
  v_mfma_f32_32x32x16_bf16 v[32:47], v[144:147], v[112:115], v[32:47]
  ds_read_b64_tr_b16 v[98:99], v9 offset:33792
  ds_read_b128 v[68:71], v12 offset:17408
  ds_read_b64_tr_b16 v[84:85], v8 offset:36864
  v_mfma_f32_32x32x16_bf16 v[16:31], v[132:135], v[116:119], v[16:31]
  ds_read_b64_tr_b16 v[86:87], v8 offset:37888
  ds_read_b64_tr_b16 v[100:101], v9 offset:36864
  ds_read_b64_tr_b16 v[102:103], v9 offset:37888
  v_mfma_f32_32x32x16_bf16 v[32:47], v[148:151], v[116:119], v[32:47]
  ds_read_b128 v[72:75], v12 offset:18432
  ds_read_b64_tr_b16 v[88:89], v8 offset:40960
  ds_read_b64_tr_b16 v[90:91], v8 offset:41984
  ds_read_b64_tr_b16 v[104:105], v9 offset:40960
  v_mfma_f32_32x32x16_bf16 v[16:31], v[136:139], v[120:123], v[16:31]
  ds_read_b64_tr_b16 v[106:107], v9 offset:41984
  ds_read_b128 v[76:79], v12 offset:19456
  ds_read_b64_tr_b16 v[92:93], v8 offset:45056
  v_mfma_f32_32x32x16_bf16 v[32:47], v[152:155], v[120:123], v[32:47]
  ds_read_b64_tr_b16 v[94:95], v8 offset:46080
  ds_read_b64_tr_b16 v[108:109], v9 offset:45056
  ds_read_b64_tr_b16 v[110:111], v9 offset:46080
  v_mfma_f32_32x32x16_bf16 v[16:31], v[140:143], v[124:127], v[16:31]
  v_mfma_f32_32x32x16_bf16 v[32:47], v[156:159], v[124:127], v[32:47]
  s_waitcnt lgkmcnt(0)
  s_barrier
  v_mfma_f32_32x32x16_bf16 v[16:31], v[80:83], v[64:67], v[16:31]
  ds_read_b128 v[112:115], v12 offset:24576
  ds_read_b64_tr_b16 v[128:129], v8 offset:49152
  ds_read_b64_tr_b16 v[130:131], v8 offset:50176
  ds_read_b64_tr_b16 v[144:145], v9 offset:49152
  v_mfma_f32_32x32x16_bf16 v[32:47], v[96:99], v[64:67], v[32:47]
  ds_read_b64_tr_b16 v[146:147], v9 offset:50176
  ds_read_b128 v[116:119], v12 offset:25600
  ds_read_b64_tr_b16 v[132:133], v8 offset:53248
  v_mfma_f32_32x32x16_bf16 v[16:31], v[84:87], v[68:71], v[16:31]
  ds_read_b64_tr_b16 v[134:135], v8 offset:54272
  ds_read_b64_tr_b16 v[148:149], v9 offset:53248
  ds_read_b64_tr_b16 v[150:151], v9 offset:54272
  v_mfma_f32_32x32x16_bf16 v[32:47], v[100:103], v[68:71], v[32:47]
  ds_read_b128 v[120:123], v12 offset:26624
  ds_read_b64_tr_b16 v[136:137], v8 offset:57344
  ds_read_b64_tr_b16 v[138:139], v8 offset:58368
  ds_read_b64_tr_b16 v[152:153], v9 offset:57344
  v_mfma_f32_32x32x16_bf16 v[16:31], v[88:91], v[72:75], v[16:31]
  ds_read_b64_tr_b16 v[154:155], v9 offset:58368
  ds_read_b128 v[124:127], v12 offset:27648
  ds_read_b64_tr_b16 v[140:141], v8 offset:61440
  v_mfma_f32_32x32x16_bf16 v[32:47], v[104:107], v[72:75], v[32:47]
  ds_read_b64_tr_b16 v[142:143], v8 offset:62464
  ds_read_b64_tr_b16 v[156:157], v9 offset:61440
  ds_read_b64_tr_b16 v[158:159], v9 offset:62464
  v_mfma_f32_32x32x16_bf16 v[16:31], v[92:95], v[76:79], v[16:31]
  v_mfma_f32_32x32x16_bf16 v[32:47], v[108:111], v[76:79], v[32:47]
  s_waitcnt lgkmcnt(0)
  v_mfma_f32_32x32x16_bf16 v[16:31], v[128:131], v[112:115], v[16:31]
  v_mfma_f32_32x32x16_bf16 v[32:47], v[144:147], v[112:115], v[32:47]
  v_mfma_f32_32x32x16_bf16 v[16:31], v[132:135], v[116:119], v[16:31]
  v_mfma_f32_32x32x16_bf16 v[32:47], v[148:151], v[116:119], v[32:47]
  v_mfma_f32_32x32x16_bf16 v[16:31], v[136:139], v[120:123], v[16:31]
  v_mfma_f32_32x32x16_bf16 v[32:47], v[152:155], v[120:123], v[32:47]
  v_mfma_f32_32x32x16_bf16 v[16:31], v[140:143], v[124:127], v[16:31]
  v_mfma_f32_32x32x16_bf16 v[32:47], v[156:159], v[124:127], v[32:47]
  s_cmp_eq_u32 s20, 1
  s_cbranch_scc1 standalone__gqa_block_cached__near_ridge_kernel_g1_29
  s_cmp_eq_u32 s20, 2
  s_cbranch_scc1 standalone__gqa_block_cached__near_ridge_kernel_g2_30
  s_cmp_eq_u32 s20, 3
  s_cbranch_scc1 standalone__gqa_block_cached__near_ridge_kernel_g3_31
standalone__gqa_block_cached__near_ridge_kernel_g0_28:
  s_nop 12
  v_cvt_pk_bf16_f32 v100, v24, v25
  v_cvt_pk_bf16_f32 v101, v26, v27
  v_cvt_pk_bf16_f32 v102, v28, v29
  v_cvt_pk_bf16_f32 v103, v30, v31
  s_add_u32 s24, s74, 8192
  buffer_store_dwordx4 v[100:103], v2, s[60:63], s24 offen sc1
  v_cvt_pk_bf16_f32 v104, v32, v33
  v_cvt_pk_bf16_f32 v105, v34, v35
  v_cvt_pk_bf16_f32 v106, v36, v37
  v_cvt_pk_bf16_f32 v107, v38, v39
  s_add_u32 s24, s74, 16384
  buffer_store_dwordx4 v[104:107], v2, s[60:63], s24 offen sc1
  v_cvt_pk_bf16_f32 v108, v40, v41
  v_cvt_pk_bf16_f32 v109, v42, v43
  v_cvt_pk_bf16_f32 v110, v44, v45
  v_cvt_pk_bf16_f32 v111, v46, v47
  s_add_u32 s24, s74, 24576
  buffer_store_dwordx4 v[108:111], v2, s[60:63], s24 offen sc1
  v_mov_b32 v64, v16
  v_mov_b32 v65, v17
  v_mov_b32 v66, v18
  v_mov_b32 v67, v19
  v_mov_b32 v68, v20
  v_mov_b32 v69, v21
  v_mov_b32 v70, v22
  v_mov_b32 v71, v23
  s_branch standalone__gqa_block_cached__near_ridge_kernel_gjoin_32
standalone__gqa_block_cached__near_ridge_kernel_g1_29:
  s_nop 12
  v_cvt_pk_bf16_f32 v100, v32, v33
  v_cvt_pk_bf16_f32 v101, v34, v35
  v_cvt_pk_bf16_f32 v102, v36, v37
  v_cvt_pk_bf16_f32 v103, v38, v39
  s_add_u32 s24, s74, 16384
  buffer_store_dwordx4 v[100:103], v2, s[60:63], s24 offen sc1
  v_cvt_pk_bf16_f32 v104, v40, v41
  v_cvt_pk_bf16_f32 v105, v42, v43
  v_cvt_pk_bf16_f32 v106, v44, v45
  v_cvt_pk_bf16_f32 v107, v46, v47
  s_add_u32 s24, s74, 24576
  buffer_store_dwordx4 v[104:107], v2, s[60:63], s24 offen sc1
  v_cvt_pk_bf16_f32 v108, v16, v17
  v_cvt_pk_bf16_f32 v109, v18, v19
  v_cvt_pk_bf16_f32 v110, v20, v21
  v_cvt_pk_bf16_f32 v111, v22, v23
  s_add_u32 s24, s74, 0
  buffer_store_dwordx4 v[108:111], v2, s[60:63], s24 offen sc1
  v_mov_b32 v64, v24
  v_mov_b32 v65, v25
  v_mov_b32 v66, v26
  v_mov_b32 v67, v27
  v_mov_b32 v68, v28
  v_mov_b32 v69, v29
  v_mov_b32 v70, v30
  v_mov_b32 v71, v31
  s_branch standalone__gqa_block_cached__near_ridge_kernel_gjoin_32
standalone__gqa_block_cached__near_ridge_kernel_g2_30:
  s_nop 12
  v_cvt_pk_bf16_f32 v100, v40, v41
  v_cvt_pk_bf16_f32 v101, v42, v43
  v_cvt_pk_bf16_f32 v102, v44, v45
  v_cvt_pk_bf16_f32 v103, v46, v47
  s_add_u32 s24, s74, 24576
  buffer_store_dwordx4 v[100:103], v2, s[60:63], s24 offen sc1
  v_cvt_pk_bf16_f32 v104, v16, v17
  v_cvt_pk_bf16_f32 v105, v18, v19
  v_cvt_pk_bf16_f32 v106, v20, v21
  v_cvt_pk_bf16_f32 v107, v22, v23
  s_add_u32 s24, s74, 0
  buffer_store_dwordx4 v[104:107], v2, s[60:63], s24 offen sc1
  v_cvt_pk_bf16_f32 v108, v24, v25
  v_cvt_pk_bf16_f32 v109, v26, v27
  v_cvt_pk_bf16_f32 v110, v28, v29
  v_cvt_pk_bf16_f32 v111, v30, v31
  s_add_u32 s24, s74, 8192
  buffer_store_dwordx4 v[108:111], v2, s[60:63], s24 offen sc1
  v_mov_b32 v64, v32
  v_mov_b32 v65, v33
  v_mov_b32 v66, v34
  v_mov_b32 v67, v35
  v_mov_b32 v68, v36
  v_mov_b32 v69, v37
  v_mov_b32 v70, v38
  v_mov_b32 v71, v39
  s_branch standalone__gqa_block_cached__near_ridge_kernel_gjoin_32
standalone__gqa_block_cached__near_ridge_kernel_g3_31:
  s_nop 12
  v_cvt_pk_bf16_f32 v100, v16, v17
  v_cvt_pk_bf16_f32 v101, v18, v19
  v_cvt_pk_bf16_f32 v102, v20, v21
  v_cvt_pk_bf16_f32 v103, v22, v23
  s_add_u32 s24, s74, 0
  buffer_store_dwordx4 v[100:103], v2, s[60:63], s24 offen sc1
  v_cvt_pk_bf16_f32 v104, v24, v25
  v_cvt_pk_bf16_f32 v105, v26, v27
  v_cvt_pk_bf16_f32 v106, v28, v29
  v_cvt_pk_bf16_f32 v107, v30, v31
  s_add_u32 s24, s74, 8192
  buffer_store_dwordx4 v[104:107], v2, s[60:63], s24 offen sc1
  v_cvt_pk_bf16_f32 v108, v32, v33
  v_cvt_pk_bf16_f32 v109, v34, v35
  v_cvt_pk_bf16_f32 v110, v36, v37
  v_cvt_pk_bf16_f32 v111, v38, v39
  s_add_u32 s24, s74, 16384
  buffer_store_dwordx4 v[108:111], v2, s[60:63], s24 offen sc1
  v_mov_b32 v64, v40
  v_mov_b32 v65, v41
  v_mov_b32 v66, v42
  v_mov_b32 v67, v43
  v_mov_b32 v68, v44
  v_mov_b32 v69, v45
  v_mov_b32 v70, v46
  v_mov_b32 v71, v47
standalone__gqa_block_cached__near_ridge_kernel_gjoin_32:
  s_waitcnt vmcnt(0)
  s_barrier
  v_mov_b32 v60, s82
  v_mov_b32 v61, 0
  s_cmp_lg_u32 s23, 0
  s_cbranch_scc1 standalone__gqa_block_cached__near_ridge_kernel_nofl_33
  s_lshl_b32 s24, s29, 7
  s_add_u32 s24, s24, 98304
  s_mov_b64 exec, 1
  buffer_store_dword v60, v61, s[68:71], s24 offen sc1
  s_mov_b64 exec, -1
standalone__gqa_block_cached__near_ridge_kernel_nofl_33:
  s_cmp_lg_u32 s23, 0
  s_cbranch_scc1 standalone__gqa_block_cached__near_ridge_kernel_pp0_34
  s_mov_b64 exec, 15
  buffer_load_dword v5, v63, s[68:71], s5 offen sc1
  s_mov_b64 exec, -1
  s_mov_b64 exec, 15
  s_mov_b32 s30, 0
standalone__gqa_block_cached__near_ridge_kernel_poll_35:
  s_waitcnt vmcnt(0)
  v_cmp_ne_u32 vcc, s82, v5
  s_add_u32 s30, s30, 1
  s_cbranch_vccz standalone__gqa_block_cached__near_ridge_kernel_pdone_36
  s_sleep 1
  buffer_load_dword v5, v63, s[68:71], s5 offen sc1
  s_cmp_lt_u32 s30, 40000
  s_cbranch_scc1 standalone__gqa_block_cached__near_ridge_kernel_poll_35
  s_waitcnt vmcnt(0)
standalone__gqa_block_cached__near_ridge_kernel_pdone_36:
  s_mov_b64 exec, -1
standalone__gqa_block_cached__near_ridge_kernel_pp0_34:
  s_barrier
  buffer_load_dwordx4 v[96:99], v2, s[60:63], s75 offen sc1
  buffer_load_dwordx4 v[100:103], v2, s[60:63], s76 offen sc1
  buffer_load_dwordx4 v[104:107], v2, s[60:63], s77 offen sc1
  s_waitcnt vmcnt(0)
  v_lshlrev_b32 v72, 16, v96
  v_and_b32 v73, 0xffff0000, v96
  v_lshlrev_b32 v74, 16, v97
  v_and_b32 v75, 0xffff0000, v97
  v_lshlrev_b32 v76, 16, v98
  v_and_b32 v77, 0xffff0000, v98
  v_lshlrev_b32 v78, 16, v99
  v_and_b32 v79, 0xffff0000, v99
  v_lshlrev_b32 v80, 16, v100
  v_and_b32 v81, 0xffff0000, v100
  v_lshlrev_b32 v82, 16, v101
  v_and_b32 v83, 0xffff0000, v101
  v_lshlrev_b32 v84, 16, v102
  v_and_b32 v85, 0xffff0000, v102
  v_lshlrev_b32 v86, 16, v103
  v_and_b32 v87, 0xffff0000, v103
  v_lshlrev_b32 v88, 16, v104
  v_and_b32 v89, 0xffff0000, v104
  v_lshlrev_b32 v90, 16, v105
  v_and_b32 v91, 0xffff0000, v105
  v_lshlrev_b32 v92, 16, v106
  v_and_b32 v93, 0xffff0000, v106
  v_lshlrev_b32 v94, 16, v107
  v_and_b32 v95, 0xffff0000, v107
  v_add_f32 v64, v64, v72
  v_add_f32 v80, v80, v88
  v_add_f32 v65, v65, v73
  v_add_f32 v81, v81, v89
  v_add_f32 v66, v66, v74
  v_add_f32 v82, v82, v90
  v_add_f32 v67, v67, v75
  v_add_f32 v83, v83, v91
  v_add_f32 v68, v68, v76
  v_add_f32 v84, v84, v92
  v_add_f32 v69, v69, v77
  v_add_f32 v85, v85, v93
  v_add_f32 v70, v70, v78
  v_add_f32 v86, v86, v94
  v_add_f32 v71, v71, v79
  v_add_f32 v87, v87, v95
  v_add_f32 v64, v64, v80
  v_add_f32 v65, v65, v81
  v_add_f32 v66, v66, v82
  v_add_f32 v67, v67, v83
  v_add_f32 v68, v68, v84
  v_add_f32 v69, v69, v85
  v_add_f32 v70, v70, v86
  v_add_f32 v71, v71, v87
  v_cvt_pk_bf16_f32 v8, v64, v65
  v_cvt_pk_bf16_f32 v9, v66, v67
  v_cvt_pk_bf16_f32 v10, v68, v69
  v_cvt_pk_bf16_f32 v11, v70, v71
  buffer_store_dwordx4 v[8:11], v3, s[64:67], s79 offen sc1
  s_cmp_lg_u32 s23, 0
  s_cbranch_scc1 standalone__gqa_block_cached__near_ridge_kernel_nofc_37
  v_mov_b32 v60, s82
  v_lshlrev_b32 v61, 7, v1
  s_lshl_b32 s24, s29, 8
  s_mov_b64 exec, 3
  buffer_store_dword v60, v61, s[68:71], s24 offen sc1
  s_lshl_b32 s24, s29, 7
  s_add_u32 s24, s24, 65536
  s_mov_b64 exec, 1
  buffer_store_dword v60, v61, s[68:71], s24 offen sc1
  s_mov_b64 exec, -1
standalone__gqa_block_cached__near_ridge_kernel_nofc_37:
  s_or_b32 s24, s20, s22
  s_or_b32 s24, s24, s23
  s_cmp_lg_u32 s24, 0
  s_cbranch_scc1 standalone__gqa_block_cached__near_ridge_kernel_noep_38
  v_mov_b32 v60, s82
  v_mov_b32 v61, 0
  s_lshl_b32 s24, s21, 7
  s_add_u32 s24, s24, 1048576
  s_mov_b64 exec, 1
  buffer_store_dword v60, v61, s[68:71], s24 offen sc1
  s_mov_b64 exec, -1
standalone__gqa_block_cached__near_ridge_kernel_noep_38:
  s_endpgm
standalone__gqa_block_cached__near_ridge_kernel_loc_11:
  s_nop 4
  buffer_store_dword v60, v61, s[68:71], s24 offen sc1
  s_branch standalone__gqa_block_cached__near_ridge_kernel_locj_12
standalone__gqa_block_cached__near_ridge_kernel_loc_22:
  s_nop 4
  buffer_store_dword v60, v61, s[68:71], s24 offen sc1
  s_branch standalone__gqa_block_cached__near_ridge_kernel_locj_23
standalone__gqa_block_cached__near_ridge_kernel_end:
  s_endpgm
.section .rodata,"a"
.p2align 6
.amdhsa_kernel standalone__gqa_block_cached__near_ridge_kernel
  .amdhsa_next_free_vgpr 256
  .amdhsa_next_free_sgpr 102
  .amdhsa_accum_offset 256
  .amdhsa_group_segment_fixed_size 0
  .amdhsa_kernarg_size 64
  .amdhsa_user_sgpr_count 2
  .amdhsa_user_sgpr_kernarg_segment_ptr 1
  .amdhsa_system_sgpr_workgroup_id_x 1
  .amdhsa_float_denorm_mode_32 3
.end_amdhsa_kernel
```
